```python
import torch

def _softmax(x, axis=-1):
    return torch.softmax(x, dim=axis)
def _gelu(x):
    return torch.nn.functional.gelu(x, approximate="tanh")
def _silu(x):
    return torch.nn.functional.silu(x)
def _sigmoid(x):
    return torch.sigmoid(x)
def _layernorm(x, axis=-1, eps=1e-5):
    m = x.mean(dim=axis, keepdim=True)
    v = x.var(dim=axis, keepdim=True, unbiased=False)
    return (x - m) / torch.sqrt(v + eps)
def _scatter_add(tgt, idx, src, axis=0):
    return tgt.clone().index_add_(axis, idx, src)
def _segment_sum(src, seg, n):
    out = torch.zeros((n,) + src.shape[1:], dtype=src.dtype)
    return out.index_add_(0, seg, src)
def _pad(x, pw):
    flat = tuple(v for pair in reversed(pw) for v in pair)
    return torch.nn.functional.pad(x, flat)

kernel_name = 'standalone__paged_block_table_kv_pagedattention__sampling'

def setup_inputs():

    _w = (lambda a: (lambda t: t.to(torch.bfloat16) if t.is_floating_point() else t)(torch.as_tensor(a)))
    B, Hq, Hkv, Sq, Skv, D = 32, 32, 8, 16, 2048, 128
    bs = 16
    nbps = max(1, Skv // bs)
    num_phys = B * nbps + 4
    bt = torch.randperm(num_phys)[: B * nbps].reshape(B, nbps).to(torch.int64)
    cl = (nbps * bs - (torch.arange(1, B + 1, dtype=torch.int64) * 2654435761) % max(1, nbps * bs // 2)).to(torch.int64)
    return {
        "q": _w((lambda *s: torch.randn(*s, dtype=torch.bfloat16) * 0.8)(B, Hq, Sq, D)),
        "k_cache": _w((lambda *s: torch.randn(*s, dtype=torch.bfloat16) * 0.8)(num_phys, bs, Hkv, D)),
        "v_cache": _w((lambda *s: torch.randn(*s, dtype=torch.bfloat16) * 0.05)(num_phys, bs, Hkv, D)),
        "block_table": _w(bt),
        "context_lens": _w(cl),
    }

def reference(q, k_cache, v_cache, block_table, context_lens):
    B, Hq, Sq, D = q.shape
    bs = k_cache.shape[1]
    Hkv = k_cache.shape[2]
    nbps = block_table.shape[1]
    Skv = nbps * bs
    bt = block_table.reshape(-1)
    k = (lambda x, *d: x.permute(*d))(k_cache[bt].reshape(B, Skv, Hkv, D), 0, 2, 1, 3)
    v = (lambda x, *d: x.permute(*d))(v_cache[bt].reshape(B, Skv, Hkv, D), 0, 2, 1, 3)
    g = Hq // Hkv
    qg = q.reshape(B, Hkv, g, Sq, D)
    scores = torch.einsum("bhgqd,bhkd->bhgqk", qg, k) * (D ** -0.5)
    pos = torch.arange(Skv)
    msk = pos[None, :] < context_lens[:, None]
    scores = torch.where(msk[:, None, None, None, :], scores, -1e9)
    p = _softmax(scores, axis=-1)
    out = torch.einsum("bhgqk,bhkd->bhgqd", p, v)
    return out.reshape(B, Hq, Sq, D)
```

```asm
; @launch grid=(256,1,1) block=(320,1,1) lds=137776
.amdgcn_target "amdgcn-amd-amdhsa--gfx950"
.text
.globl standalone__paged_block_table_kv_pagedattention__sampling_kernel
.p2align 8
.type standalone__paged_block_table_kv_pagedattention__sampling_kernel,@function
standalone__paged_block_table_kv_pagedattention__sampling_kernel:
    s_cmp_ge_u32 s2, 256
    s_cbranch_scc1 L_done
    s_load_dwordx16 s[4:19], s[0:1], 0
    v_lshrrev_b32 v1, 6, v0
    s_lshr_b32 s20, s2, 3
    v_readfirstlane_b32 s3, v1
    s_and_b32 s21, s2, 7
    v_and_b32 v1, 63, v0
    s_cmp_eq_u32 s3, 0
    s_cbranch_scc0 L_consumer
    s_setprio 3
    v_lshlrev_b32 v2, 4, v1
    v_lshlrev_b32 v3, 2, v1
    s_lshl_b32 s22, s20, 9
    s_mov_b32 s34, 16384
    s_mov_b32 s35, 0x20000
    s_mov_b32 s38, 128
    s_mov_b32 s39, 0x20000
    v_mov_b32 v32, 0
    v_mov_b32 v33, 0
    v_mov_b32 v34, 0
    v_mov_b32 v35, 0
    v_mov_b32 v36, 137216
    ds_write_b128 v36, v[32:35]
    ds_write_b32 v36, v32 offset:16
    ds_write_b128 v36, v[32:35] offset:32
    s_waitcnt lgkmcnt(0)
    s_mov_b32 s32, s10
    s_mov_b32 s33, s11
    s_mov_b32 s36, s12
    s_mov_b32 s37, s13
    buffer_load_dwordx4 v[20:23], v2, s[32:35], s22 offen
    buffer_load_dword v19, v3, s[36:39], 0 offen
    s_mov_b32 s26, 134348800
    s_mov_b32 s27, 0x20000
    s_mov_b32 s30, 134348800
    s_mov_b32 s31, 0x20000
    s_mov_b32 s24, s6
    s_mov_b32 s25, s7
    s_mov_b32 s28, s8
    s_mov_b32 s29, s9
    v_lshrrev_b32 v4, 4, v1
    v_and_b32 v5, 15, v1
    s_lshl_b32 s23, s21, 8
    v_lshlrev_b32 v6, 11, v4
    v_add_u32 v6, s23, v6
    v_xor_b32 v7, v5, v4
    v_lshl_add_u32 v24, v7, 4, v6
    v_lshlrev_b32 v7, 2, v4
    v_xor_b32 v7, v5, v7
    v_lshl_add_u32 v28, v7, 4, v6
    v_add_u32 v25, 7104, v24
    v_add_u32 v29, 7136, v28
    v_add_u32 v26, 7104, v25
    v_add_u32 v30, 7136, v29
    v_add_u32 v27, 7104, v26
    v_add_u32 v31, 7136, v30
    v_or_b32 v9, 1, v3
    v_or_b32 v10, 2, v3
    v_or_b32 v11, 3, v3
    v_mov_b32 v12, 0x80000000
    v_mov_b32 v13, 2048
    v_and_b32 v39, 0x1f0, v2
    v_add_u32 v39, 137264, v39
    s_mov_b32 s53, 0
    s_mov_b32 s54, 69632
    s_mov_b32 m0, 0
    s_waitcnt vmcnt(1)
    v_lshlrev_b32 v20, 15, v20
    v_lshlrev_b32 v21, 15, v21
    v_readlane_b32 s60, v20, 0
    v_lshlrev_b32 v22, 15, v22
    v_lshlrev_b32 v23, 15, v23
    s_waitcnt vmcnt(0)
    v_cmp_ge_i32 vcc, 0, v19
    s_nop 0
    buffer_load_dwordx4 v24, s[24:27], s60 offen offset:0 nt lds
    buffer_load_dwordx4 v25, s[24:27], s60 offen offset:1088 nt lds
    buffer_load_dwordx4 v26, s[24:27], s60 offen offset:2176 nt lds
    buffer_load_dwordx4 v27, s[24:27], s60 offen offset:3264 nt lds
    v_cndmask_b32 v19, v19, v13, vcc
    v_min_i32 v19, v19, v13
    v_add_u32 v19, 15, v19
    v_lshrrev_b32 v19, 4, v19
    s_nop 0
    v_readlane_b32 s48, v19, s20
    s_nop 1
    v_cmp_gt_u32 s[40:41], s48, v3
    v_cmp_gt_u32 s[42:43], s48, v9
    v_cmp_gt_u32 s[44:45], s48, v10
    v_cmp_gt_u32 s[46:47], s48, v11
    v_cndmask_b32 v21, v12, v21, s[42:43]
    v_cndmask_b32 v22, v12, v22, s[44:45]
    v_cndmask_b32 v23, v12, v23, s[46:47]
    v_cndmask_b32 v20, v12, v20, s[40:41]
    s_mov_b32 m0, 4352
    v_readlane_b32 s61, v21, 0
    v_readlane_b32 s62, v22, 0
    v_readlane_b32 s63, v23, 0
    v_readlane_b32 s56, v20, 1
    v_readlane_b32 s57, v21, 1
    v_readlane_b32 s58, v22, 1
    v_readlane_b32 s59, v23, 1
    buffer_load_dwordx4 v24, s[24:27], s61 offen offset:0 nt lds
    buffer_load_dwordx4 v25, s[24:27], s61 offen offset:1088 nt lds
    buffer_load_dwordx4 v26, s[24:27], s61 offen offset:2176 nt lds
    buffer_load_dwordx4 v27, s[24:27], s61 offen offset:3264 nt lds
    s_barrier
    s_add_u32 s51, s48, 3
    s_lshr_b32 s51, s51, 2
    s_mov_b32 s50, 1
    s_mov_b32 s52, 0
    v_add_u32_dpp v19, v19, v19 row_shr:1 row_mask:0xf bank_mask:0xf bound_ctrl:0
    s_nop 1
    v_add_u32_dpp v19, v19, v19 row_shr:2 row_mask:0xf bank_mask:0xf bound_ctrl:0
    s_nop 1
    v_add_u32_dpp v19, v19, v19 row_shr:4 row_mask:0xf bank_mask:0xf bound_ctrl:0
    s_nop 1
    v_add_u32_dpp v19, v19, v19 row_shr:8 row_mask:0xf bank_mask:0xf bound_ctrl:0
    v_cvt_f32_u32 v14, s48
    v_readlane_b32 s46, v19, 15
    v_readlane_b32 s47, v19, 31
    v_log_f32 v14, v14
    s_add_u32 s46, s46, s47
    v_cvt_f32_u32 v15, s46
    v_log_f32 v15, v15
    v_mov_b32 v16, 0x411ff783
    v_sub_f32 v14, v14, v15
    v_fmac_f32 v16, 0x3f933333, v14
    v_exp_f32 v16, v16
    s_and_b32 s46, s21, 3
    s_cmp_eq_u32 s46, 1
    s_cselect_b32 s46, 0x40000000, 0x00000000
    v_subrev_f32 v15, 0x41b00000, v16
    v_max_f32 v15, 0, v15
    v_fmac_f32 v16, s46, v15
    v_add_f32 v16, 0.5, v16
    v_cvt_u32_f32 v16, v16
    s_nop 0
    v_readfirstlane_b32 s49, v16
    s_nop 0
    s_max_u32 s49, s49, 10
    s_min_u32 s49, s49, 34
    s_cmp_ge_u32 s49, 22
    s_cbranch_scc1 L_tree22_34
    s_cmp_ge_u32 s49, 16
    s_cbranch_scc1 L_tree16_21
    s_cmp_ge_u32 s49, 13
    s_cbranch_scc1 L_tree13_15
    s_cmp_ge_u32 s49, 11
    s_cbranch_scc1 L_tree11_12
    s_branch L_pro10
L_tree11_12:
    s_cmp_ge_u32 s49, 12
    s_cbranch_scc1 L_tree12_12
    s_branch L_pro11
L_tree12_12:
    s_branch L_pro12
L_tree13_15:
    s_cmp_ge_u32 s49, 14
    s_cbranch_scc1 L_tree14_15
    s_branch L_pro13
L_tree14_15:
    s_cmp_ge_u32 s49, 15
    s_cbranch_scc1 L_tree15_15
    s_branch L_pro14
L_tree15_15:
    s_branch L_pro15
L_tree16_21:
    s_cmp_ge_u32 s49, 19
    s_cbranch_scc1 L_tree19_21
    s_cmp_ge_u32 s49, 17
    s_cbranch_scc1 L_tree17_18
    s_branch L_pro16
L_tree17_18:
    s_cmp_ge_u32 s49, 18
    s_cbranch_scc1 L_tree18_18
    s_branch L_pro17
L_tree18_18:
    s_branch L_pro18
L_tree19_21:
    s_cmp_ge_u32 s49, 20
    s_cbranch_scc1 L_tree20_21
    s_branch L_pro19
L_tree20_21:
    s_cmp_ge_u32 s49, 21
    s_cbranch_scc1 L_tree21_21
    s_branch L_pro20
L_tree21_21:
    s_branch L_pro21
L_tree22_34:
    s_cmp_ge_u32 s49, 28
    s_cbranch_scc1 L_tree28_34
    s_cmp_ge_u32 s49, 25
    s_cbranch_scc1 L_tree25_27
    s_cmp_ge_u32 s49, 23
    s_cbranch_scc1 L_tree23_24
    s_branch L_pro22
L_tree23_24:
    s_cmp_ge_u32 s49, 24
    s_cbranch_scc1 L_tree24_24
    s_branch L_pro23
L_tree24_24:
    s_branch L_pro24
L_tree25_27:
    s_cmp_ge_u32 s49, 26
    s_cbranch_scc1 L_tree26_27
    s_branch L_pro25
L_tree26_27:
    s_cmp_ge_u32 s49, 27
    s_cbranch_scc1 L_tree27_27
    s_branch L_pro26
L_tree27_27:
    s_branch L_pro27
L_tree28_34:
    s_cmp_ge_u32 s49, 31
    s_cbranch_scc1 L_tree31_34
    s_cmp_ge_u32 s49, 29
    s_cbranch_scc1 L_tree29_30
    s_branch L_pro28
L_tree29_30:
    s_cmp_ge_u32 s49, 30
    s_cbranch_scc1 L_tree30_30
    s_branch L_pro29
L_tree30_30:
    s_branch L_pro30
L_tree31_34:
    s_cmp_ge_u32 s49, 33
    s_cbranch_scc1 L_tree33_34
    s_cmp_ge_u32 s49, 32
    s_cbranch_scc1 L_tree32_32
    s_branch L_pro31
L_tree32_32:
    s_branch L_pro32
L_tree33_34:
    s_cmp_ge_u32 s49, 34
    s_cbranch_scc1 L_tree34_34
    s_branch L_pro33
L_tree34_34:
    s_branch L_pro34
L_pro10:
    s_mov_b32 m0, 8704
    s_nop 0
    buffer_load_dwordx4 v24, s[24:27], s62 offen offset:0 nt lds
    buffer_load_dwordx4 v25, s[24:27], s62 offen offset:1088 nt lds
    s_waitcnt vmcnt(9)
    buffer_load_dwordx4 v26, s[24:27], s62 offen offset:2176 nt lds
    s_waitcnt vmcnt(9)
    buffer_load_dwordx4 v27, s[24:27], s62 offen offset:3264 nt lds
    s_mov_b32 m0, 13056
    s_waitcnt vmcnt(9)
    buffer_load_dwordx4 v24, s[24:27], s63 offen offset:0 nt lds
    s_waitcnt vmcnt(9)
    buffer_load_dwordx4 v25, s[24:27], s63 offen offset:1088 nt lds
    s_waitcnt vmcnt(9)
    buffer_load_dwordx4 v26, s[24:27], s63 offen offset:2176 nt lds
    s_waitcnt vmcnt(9)
    buffer_load_dwordx4 v27, s[24:27], s63 offen offset:3264 nt lds
    s_mov_b32 s53, 17408
    s_cmp_ge_u32 s50, s51
    s_cbranch_scc1 L_tail10
L_loop10:
    s_sub_i32 s48, s50, 3
    s_branch L_fchka10
L_fspina10:
    ds_read_b128 v[32:35], v36
L_fchka10:
    s_waitcnt lgkmcnt(0)
    v_min_u32 v32, v32, v33
    v_min3_u32 v32, v32, v34, v35
    s_nop 0
    v_readfirstlane_b32 s47, v32
    s_nop 0
    s_cmp_ge_i32 s47, s48
    s_cbranch_scc0 L_fspina10
    s_add_u32 m0, s53, 0
    s_waitcnt vmcnt(9)
    buffer_load_dwordx4 v24, s[24:27], s56 offen offset:0 nt lds
    s_waitcnt vmcnt(9)
    buffer_load_dwordx4 v25, s[24:27], s56 offen offset:1088 nt lds
    s_waitcnt vmcnt(9)
    buffer_load_dwordx4 v26, s[24:27], s56 offen offset:2176 nt lds
    s_waitcnt vmcnt(9)
    buffer_load_dwordx4 v27, s[24:27], s56 offen offset:3264 nt lds
    s_add_u32 m0, s53, 4352
    s_waitcnt vmcnt(9)
    buffer_load_dwordx4 v24, s[24:27], s57 offen offset:0 nt lds
    s_waitcnt vmcnt(9)
    buffer_load_dwordx4 v25, s[24:27], s57 offen offset:1088 nt lds
    s_waitcnt vmcnt(9)
    buffer_load_dwordx4 v26, s[24:27], s57 offen offset:2176 nt lds
    s_waitcnt vmcnt(9)
    buffer_load_dwordx4 v27, s[24:27], s57 offen offset:3264 nt lds
    s_add_u32 m0, s53, 8704
    s_waitcnt vmcnt(9)
    buffer_load_dwordx4 v24, s[24:27], s58 offen offset:0 nt lds
    s_waitcnt vmcnt(9)
    s_lshl1_add_u32 s52, s50, -1
    v_mov_b32 v37, s52
    ds_write_b32 v36, v37 offset:16
    buffer_load_dwordx4 v25, s[24:27], s58 offen offset:1088 nt lds
    s_waitcnt vmcnt(9)
    buffer_load_dwordx4 v26, s[24:27], s58 offen offset:2176 nt lds
    s_waitcnt vmcnt(9)
    buffer_load_dwordx4 v27, s[24:27], s58 offen offset:3264 nt lds
    s_add_u32 m0, s53, 13056
    s_waitcnt vmcnt(9)
    buffer_load_dwordx4 v24, s[24:27], s59 offen offset:0 nt lds
    s_waitcnt vmcnt(9)
    buffer_load_dwordx4 v25, s[24:27], s59 offen offset:1088 nt lds
    s_waitcnt vmcnt(9)
    buffer_load_dwordx4 v26, s[24:27], s59 offen offset:2176 nt lds
    s_waitcnt vmcnt(9)
    buffer_load_dwordx4 v27, s[24:27], s59 offen offset:3264 nt lds
    s_add_u32 m0, s54, 0
    s_waitcnt vmcnt(9)
    buffer_load_dwordx4 v28, s[28:31], s60 offen offset:0 nt lds
    s_waitcnt vmcnt(9)
    buffer_load_dwordx4 v29, s[28:31], s60 offen offset:1056 nt lds
    s_waitcnt vmcnt(9)
    buffer_load_dwordx4 v30, s[28:31], s60 offen offset:2112 nt lds
    s_waitcnt vmcnt(9)
    buffer_load_dwordx4 v31, s[28:31], s60 offen offset:3168 nt lds
    s_add_u32 m0, s54, 4224
    s_waitcnt vmcnt(9)
    buffer_load_dwordx4 v28, s[28:31], s61 offen offset:0 nt lds
    s_waitcnt vmcnt(9)
    buffer_load_dwordx4 v29, s[28:31], s61 offen offset:1056 nt lds
    s_waitcnt vmcnt(9)
    buffer_load_dwordx4 v30, s[28:31], s61 offen offset:2112 nt lds
    s_waitcnt vmcnt(9)
    buffer_load_dwordx4 v31, s[28:31], s61 offen offset:3168 nt lds
    s_add_u32 m0, s54, 8448
    s_waitcnt vmcnt(9)
    buffer_load_dwordx4 v28, s[28:31], s62 offen offset:0 nt lds
    s_waitcnt vmcnt(9)
    s_lshl1_add_u32 s52, s50, 0
    v_mov_b32 v37, s52
    ds_write_b32 v36, v37 offset:16
    buffer_load_dwordx4 v29, s[28:31], s62 offen offset:1056 nt lds
    s_waitcnt vmcnt(9)
    buffer_load_dwordx4 v30, s[28:31], s62 offen offset:2112 nt lds
    s_waitcnt vmcnt(9)
    ds_read_b128 v[32:35], v36
    buffer_load_dwordx4 v31, s[28:31], s62 offen offset:3168 nt lds
    s_add_u32 m0, s54, 12672
    s_waitcnt vmcnt(9)
    buffer_load_dwordx4 v28, s[28:31], s63 offen offset:0 nt lds
    s_waitcnt vmcnt(9)
    buffer_load_dwordx4 v29, s[28:31], s63 offen offset:1056 nt lds
    s_waitcnt vmcnt(9)
    buffer_load_dwordx4 v30, s[28:31], s63 offen offset:2112 nt lds
    s_waitcnt vmcnt(9)
    buffer_load_dwordx4 v31, s[28:31], s63 offen offset:3168 nt lds
    s_add_u32 s50, s50, 1
    s_mov_b64 s[60:61], s[56:57]
    s_mov_b64 s[62:63], s[58:59]
    s_cmp_eq_u32 s50, 2
    s_cbranch_scc0 L_tab10
L_tw10:
    ds_read_b128 v[40:43], v36 offset:32
    ds_read_b128 v[20:23], v39
    s_waitcnt lgkmcnt(0)
    v_min3_u32 v40, v40, v41, v42
    v_min_u32 v40, v40, v43
    s_nop 0
    v_readfirstlane_b32 s47, v40
    s_nop 0
    s_cmp_eq_u32 s47, 0
    s_cbranch_scc1 L_tw10
L_tab10:
    v_readlane_b32 s56, v20, s50
    v_readlane_b32 s57, v21, s50
    v_readlane_b32 s58, v22, s50
    v_readlane_b32 s59, v23, s50
    s_add_u32 s53, s53, 17408
    s_cmp_ge_u32 s53, 69632
    s_cselect_b32 s53, 0, s53
    s_add_u32 s54, s54, 16896
    s_cmp_ge_u32 s54, 137216
    s_cselect_b32 s54, 69632, s54
    s_cmp_lt_u32 s50, s51
    s_cbranch_scc1 L_loop10
L_tail10:
    s_sub_i32 s48, s50, 3
    s_branch L_fchkb10
L_fspinb10:
    ds_read_b128 v[32:35], v36
L_fchkb10:
    s_waitcnt lgkmcnt(0)
    v_min_u32 v32, v32, v33
    v_min3_u32 v32, v32, v34, v35
    s_nop 0
    v_readfirstlane_b32 s47, v32
    s_nop 0
    s_cmp_ge_i32 s47, s48
    s_cbranch_scc0 L_fspinb10
    s_add_u32 m0, s54, 0
    s_waitcnt vmcnt(9)
    buffer_load_dwordx4 v28, s[28:31], s60 offen offset:0 nt lds
    s_waitcnt vmcnt(9)
    buffer_load_dwordx4 v29, s[28:31], s60 offen offset:1056 nt lds
    s_waitcnt vmcnt(9)
    buffer_load_dwordx4 v30, s[28:31], s60 offen offset:2112 nt lds
    s_waitcnt vmcnt(9)
    buffer_load_dwordx4 v31, s[28:31], s60 offen offset:3168 nt lds
    s_add_u32 m0, s54, 4224
    s_waitcnt vmcnt(9)
    buffer_load_dwordx4 v28, s[28:31], s61 offen offset:0 nt lds
    s_waitcnt vmcnt(9)
    buffer_load_dwordx4 v29, s[28:31], s61 offen offset:1056 nt lds
    s_waitcnt vmcnt(9)
    buffer_load_dwordx4 v30, s[28:31], s61 offen offset:2112 nt lds
    s_waitcnt vmcnt(9)
    buffer_load_dwordx4 v31, s[28:31], s61 offen offset:3168 nt lds
    s_add_u32 m0, s54, 8448
    s_waitcnt vmcnt(9)
    buffer_load_dwordx4 v28, s[28:31], s62 offen offset:0 nt lds
    s_waitcnt vmcnt(9)
    s_lshl1_add_u32 s52, s50, -1
    v_mov_b32 v37, s52
    ds_write_b32 v36, v37 offset:16
    buffer_load_dwordx4 v29, s[28:31], s62 offen offset:1056 nt lds
    s_waitcnt vmcnt(9)
    buffer_load_dwordx4 v30, s[28:31], s62 offen offset:2112 nt lds
    s_waitcnt vmcnt(9)
    buffer_load_dwordx4 v31, s[28:31], s62 offen offset:3168 nt lds
    s_add_u32 m0, s54, 12672
    s_waitcnt vmcnt(9)
    buffer_load_dwordx4 v28, s[28:31], s63 offen offset:0 nt lds
    s_waitcnt vmcnt(9)
    buffer_load_dwordx4 v29, s[28:31], s63 offen offset:1056 nt lds
    s_waitcnt vmcnt(9)
    buffer_load_dwordx4 v30, s[28:31], s63 offen offset:2112 nt lds
    s_waitcnt vmcnt(9)
    buffer_load_dwordx4 v31, s[28:31], s63 offen offset:3168 nt lds
    s_branch L_drain
L_pro11:
    s_mov_b32 m0, 8704
    s_nop 0
    buffer_load_dwordx4 v24, s[24:27], s62 offen offset:0 nt lds
    buffer_load_dwordx4 v25, s[24:27], s62 offen offset:1088 nt lds
    buffer_load_dwordx4 v26, s[24:27], s62 offen offset:2176 nt lds
    s_waitcnt vmcnt(10)
    buffer_load_dwordx4 v27, s[24:27], s62 offen offset:3264 nt lds
    s_mov_b32 m0, 13056
    s_waitcnt vmcnt(10)
    buffer_load_dwordx4 v24, s[24:27], s63 offen offset:0 nt lds
    s_waitcnt vmcnt(10)
    buffer_load_dwordx4 v25, s[24:27], s63 offen offset:1088 nt lds
    s_waitcnt vmcnt(10)
    buffer_load_dwordx4 v26, s[24:27], s63 offen offset:2176 nt lds
    s_waitcnt vmcnt(10)
    buffer_load_dwordx4 v27, s[24:27], s63 offen offset:3264 nt lds
    s_mov_b32 s53, 17408
    s_cmp_ge_u32 s50, s51
    s_cbranch_scc1 L_tail11
L_loop11:
    s_sub_i32 s48, s50, 3
    s_branch L_fchka11
L_fspina11:
    ds_read_b128 v[32:35], v36
L_fchka11:
    s_waitcnt lgkmcnt(0)
    v_min_u32 v32, v32, v33
    v_min3_u32 v32, v32, v34, v35
    s_nop 0
    v_readfirstlane_b32 s47, v32
    s_nop 0
    s_cmp_ge_i32 s47, s48
    s_cbranch_scc0 L_fspina11
    s_add_u32 m0, s53, 0
    s_waitcnt vmcnt(10)
    buffer_load_dwordx4 v24, s[24:27], s56 offen offset:0 nt lds
    s_waitcnt vmcnt(10)
    buffer_load_dwordx4 v25, s[24:27], s56 offen offset:1088 nt lds
    s_waitcnt vmcnt(10)
    buffer_load_dwordx4 v26, s[24:27], s56 offen offset:2176 nt lds
    s_waitcnt vmcnt(10)
    buffer_load_dwordx4 v27, s[24:27], s56 offen offset:3264 nt lds
    s_add_u32 m0, s53, 4352
    s_waitcnt vmcnt(10)
    buffer_load_dwordx4 v24, s[24:27], s57 offen offset:0 nt lds
    s_waitcnt vmcnt(10)
    buffer_load_dwordx4 v25, s[24:27], s57 offen offset:1088 nt lds
    s_waitcnt vmcnt(10)
    buffer_load_dwordx4 v26, s[24:27], s57 offen offset:2176 nt lds
    s_waitcnt vmcnt(10)
    buffer_load_dwordx4 v27, s[24:27], s57 offen offset:3264 nt lds
    s_add_u32 m0, s53, 8704
    s_waitcnt vmcnt(10)
    buffer_load_dwordx4 v24, s[24:27], s58 offen offset:0 nt lds
    s_waitcnt vmcnt(10)
    buffer_load_dwordx4 v25, s[24:27], s58 offen offset:1088 nt lds
    s_waitcnt vmcnt(10)
    s_lshl1_add_u32 s52, s50, -1
    v_mov_b32 v37, s52
    ds_write_b32 v36, v37 offset:16
    buffer_load_dwordx4 v26, s[24:27], s58 offen offset:2176 nt lds
    s_waitcnt vmcnt(10)
    buffer_load_dwordx4 v27, s[24:27], s58 offen offset:3264 nt lds
    s_add_u32 m0, s53, 13056
    s_waitcnt vmcnt(10)
    buffer_load_dwordx4 v24, s[24:27], s59 offen offset:0 nt lds
    s_waitcnt vmcnt(10)
    buffer_load_dwordx4 v25, s[24:27], s59 offen offset:1088 nt lds
    s_waitcnt vmcnt(10)
    buffer_load_dwordx4 v26, s[24:27], s59 offen offset:2176 nt lds
    s_waitcnt vmcnt(10)
    buffer_load_dwordx4 v27, s[24:27], s59 offen offset:3264 nt lds
    s_add_u32 m0, s54, 0
    s_waitcnt vmcnt(10)
    buffer_load_dwordx4 v28, s[28:31], s60 offen offset:0 nt lds
    s_waitcnt vmcnt(10)
    buffer_load_dwordx4 v29, s[28:31], s60 offen offset:1056 nt lds
    s_waitcnt vmcnt(10)
    buffer_load_dwordx4 v30, s[28:31], s60 offen offset:2112 nt lds
    s_waitcnt vmcnt(10)
    buffer_load_dwordx4 v31, s[28:31], s60 offen offset:3168 nt lds
    s_add_u32 m0, s54, 4224
    s_waitcnt vmcnt(10)
    buffer_load_dwordx4 v28, s[28:31], s61 offen offset:0 nt lds
    s_waitcnt vmcnt(10)
    buffer_load_dwordx4 v29, s[28:31], s61 offen offset:1056 nt lds
    s_waitcnt vmcnt(10)
    buffer_load_dwordx4 v30, s[28:31], s61 offen offset:2112 nt lds
    s_waitcnt vmcnt(10)
    buffer_load_dwordx4 v31, s[28:31], s61 offen offset:3168 nt lds
    s_add_u32 m0, s54, 8448
    s_waitcnt vmcnt(10)
    buffer_load_dwordx4 v28, s[28:31], s62 offen offset:0 nt lds
    s_waitcnt vmcnt(10)
    buffer_load_dwordx4 v29, s[28:31], s62 offen offset:1056 nt lds
    s_waitcnt vmcnt(10)
    s_lshl1_add_u32 s52, s50, 0
    v_mov_b32 v37, s52
    ds_write_b32 v36, v37 offset:16
    buffer_load_dwordx4 v30, s[28:31], s62 offen offset:2112 nt lds
    s_waitcnt vmcnt(10)
    ds_read_b128 v[32:35], v36
    buffer_load_dwordx4 v31, s[28:31], s62 offen offset:3168 nt lds
    s_add_u32 m0, s54, 12672
    s_waitcnt vmcnt(10)
    buffer_load_dwordx4 v28, s[28:31], s63 offen offset:0 nt lds
    s_waitcnt vmcnt(10)
    buffer_load_dwordx4 v29, s[28:31], s63 offen offset:1056 nt lds
    s_waitcnt vmcnt(10)
    buffer_load_dwordx4 v30, s[28:31], s63 offen offset:2112 nt lds
    s_waitcnt vmcnt(10)
    buffer_load_dwordx4 v31, s[28:31], s63 offen offset:3168 nt lds
    s_add_u32 s50, s50, 1
    s_mov_b64 s[60:61], s[56:57]
    s_mov_b64 s[62:63], s[58:59]
    s_cmp_eq_u32 s50, 2
    s_cbranch_scc0 L_tab11
L_tw11:
    ds_read_b128 v[40:43], v36 offset:32
    ds_read_b128 v[20:23], v39
    s_waitcnt lgkmcnt(0)
    v_min3_u32 v40, v40, v41, v42
    v_min_u32 v40, v40, v43
    s_nop 0
    v_readfirstlane_b32 s47, v40
    s_nop 0
    s_cmp_eq_u32 s47, 0
    s_cbranch_scc1 L_tw11
L_tab11:
    v_readlane_b32 s56, v20, s50
    v_readlane_b32 s57, v21, s50
    v_readlane_b32 s58, v22, s50
    v_readlane_b32 s59, v23, s50
    s_add_u32 s53, s53, 17408
    s_cmp_ge_u32 s53, 69632
    s_cselect_b32 s53, 0, s53
    s_add_u32 s54, s54, 16896
    s_cmp_ge_u32 s54, 137216
    s_cselect_b32 s54, 69632, s54
    s_cmp_lt_u32 s50, s51
    s_cbranch_scc1 L_loop11
L_tail11:
    s_sub_i32 s48, s50, 3
    s_branch L_fchkb11
L_fspinb11:
    ds_read_b128 v[32:35], v36
L_fchkb11:
    s_waitcnt lgkmcnt(0)
    v_min_u32 v32, v32, v33
    v_min3_u32 v32, v32, v34, v35
    s_nop 0
    v_readfirstlane_b32 s47, v32
    s_nop 0
    s_cmp_ge_i32 s47, s48
    s_cbranch_scc0 L_fspinb11
    s_add_u32 m0, s54, 0
    s_waitcnt vmcnt(10)
    buffer_load_dwordx4 v28, s[28:31], s60 offen offset:0 nt lds
    s_waitcnt vmcnt(10)
    buffer_load_dwordx4 v29, s[28:31], s60 offen offset:1056 nt lds
    s_waitcnt vmcnt(10)
    buffer_load_dwordx4 v30, s[28:31], s60 offen offset:2112 nt lds
    s_waitcnt vmcnt(10)
    buffer_load_dwordx4 v31, s[28:31], s60 offen offset:3168 nt lds
    s_add_u32 m0, s54, 4224
    s_waitcnt vmcnt(10)
    buffer_load_dwordx4 v28, s[28:31], s61 offen offset:0 nt lds
    s_waitcnt vmcnt(10)
    buffer_load_dwordx4 v29, s[28:31], s61 offen offset:1056 nt lds
    s_waitcnt vmcnt(10)
    buffer_load_dwordx4 v30, s[28:31], s61 offen offset:2112 nt lds
    s_waitcnt vmcnt(10)
    buffer_load_dwordx4 v31, s[28:31], s61 offen offset:3168 nt lds
    s_add_u32 m0, s54, 8448
    s_waitcnt vmcnt(10)
    buffer_load_dwordx4 v28, s[28:31], s62 offen offset:0 nt lds
    s_waitcnt vmcnt(10)
    buffer_load_dwordx4 v29, s[28:31], s62 offen offset:1056 nt lds
    s_waitcnt vmcnt(10)
    s_lshl1_add_u32 s52, s50, -1
    v_mov_b32 v37, s52
    ds_write_b32 v36, v37 offset:16
    buffer_load_dwordx4 v30, s[28:31], s62 offen offset:2112 nt lds
    s_waitcnt vmcnt(10)
    buffer_load_dwordx4 v31, s[28:31], s62 offen offset:3168 nt lds
    s_add_u32 m0, s54, 12672
    s_waitcnt vmcnt(10)
    buffer_load_dwordx4 v28, s[28:31], s63 offen offset:0 nt lds
    s_waitcnt vmcnt(10)
    buffer_load_dwordx4 v29, s[28:31], s63 offen offset:1056 nt lds
    s_waitcnt vmcnt(10)
    buffer_load_dwordx4 v30, s[28:31], s63 offen offset:2112 nt lds
    s_waitcnt vmcnt(10)
    buffer_load_dwordx4 v31, s[28:31], s63 offen offset:3168 nt lds
    s_branch L_drain
L_pro12:
    s_mov_b32 m0, 8704
    s_nop 0
    buffer_load_dwordx4 v24, s[24:27], s62 offen offset:0 nt lds
    buffer_load_dwordx4 v25, s[24:27], s62 offen offset:1088 nt lds
    buffer_load_dwordx4 v26, s[24:27], s62 offen offset:2176 nt lds
    buffer_load_dwordx4 v27, s[24:27], s62 offen offset:3264 nt lds
    s_mov_b32 m0, 13056
    s_waitcnt vmcnt(11)
    buffer_load_dwordx4 v24, s[24:27], s63 offen offset:0 nt lds
    s_waitcnt vmcnt(11)
    buffer_load_dwordx4 v25, s[24:27], s63 offen offset:1088 nt lds
    s_waitcnt vmcnt(11)
    buffer_load_dwordx4 v26, s[24:27], s63 offen offset:2176 nt lds
    s_waitcnt vmcnt(11)
    buffer_load_dwordx4 v27, s[24:27], s63 offen offset:3264 nt lds
    s_mov_b32 s53, 17408
    s_cmp_ge_u32 s50, s51
    s_cbranch_scc1 L_tail12
L_loop12:
    s_sub_i32 s48, s50, 3
    s_branch L_fchka12
L_fspina12:
    ds_read_b128 v[32:35], v36
L_fchka12:
    s_waitcnt lgkmcnt(0)
    v_min_u32 v32, v32, v33
    v_min3_u32 v32, v32, v34, v35
    s_nop 0
    v_readfirstlane_b32 s47, v32
    s_nop 0
    s_cmp_ge_i32 s47, s48
    s_cbranch_scc0 L_fspina12
    s_add_u32 m0, s53, 0
    s_waitcnt vmcnt(11)
    buffer_load_dwordx4 v24, s[24:27], s56 offen offset:0 nt lds
    s_waitcnt vmcnt(11)
    buffer_load_dwordx4 v25, s[24:27], s56 offen offset:1088 nt lds
    s_waitcnt vmcnt(11)
    buffer_load_dwordx4 v26, s[24:27], s56 offen offset:2176 nt lds
    s_waitcnt vmcnt(11)
    buffer_load_dwordx4 v27, s[24:27], s56 offen offset:3264 nt lds
    s_add_u32 m0, s53, 4352
    s_waitcnt vmcnt(11)
    buffer_load_dwordx4 v24, s[24:27], s57 offen offset:0 nt lds
    s_waitcnt vmcnt(11)
    buffer_load_dwordx4 v25, s[24:27], s57 offen offset:1088 nt lds
    s_waitcnt vmcnt(11)
    buffer_load_dwordx4 v26, s[24:27], s57 offen offset:2176 nt lds
    s_waitcnt vmcnt(11)
    buffer_load_dwordx4 v27, s[24:27], s57 offen offset:3264 nt lds
    s_add_u32 m0, s53, 8704
    s_waitcnt vmcnt(11)
    buffer_load_dwordx4 v24, s[24:27], s58 offen offset:0 nt lds
    s_waitcnt vmcnt(11)
    buffer_load_dwordx4 v25, s[24:27], s58 offen offset:1088 nt lds
    s_waitcnt vmcnt(11)
    buffer_load_dwordx4 v26, s[24:27], s58 offen offset:2176 nt lds
    s_waitcnt vmcnt(11)
    s_lshl1_add_u32 s52, s50, -1
    v_mov_b32 v37, s52
    ds_write_b32 v36, v37 offset:16
    buffer_load_dwordx4 v27, s[24:27], s58 offen offset:3264 nt lds
    s_add_u32 m0, s53, 13056
    s_waitcnt vmcnt(11)
    buffer_load_dwordx4 v24, s[24:27], s59 offen offset:0 nt lds
    s_waitcnt vmcnt(11)
    buffer_load_dwordx4 v25, s[24:27], s59 offen offset:1088 nt lds
    s_waitcnt vmcnt(11)
    buffer_load_dwordx4 v26, s[24:27], s59 offen offset:2176 nt lds
    s_waitcnt vmcnt(11)
    buffer_load_dwordx4 v27, s[24:27], s59 offen offset:3264 nt lds
    s_add_u32 m0, s54, 0
    s_waitcnt vmcnt(11)
    buffer_load_dwordx4 v28, s[28:31], s60 offen offset:0 nt lds
    s_waitcnt vmcnt(11)
    buffer_load_dwordx4 v29, s[28:31], s60 offen offset:1056 nt lds
    s_waitcnt vmcnt(11)
    buffer_load_dwordx4 v30, s[28:31], s60 offen offset:2112 nt lds
    s_waitcnt vmcnt(11)
    buffer_load_dwordx4 v31, s[28:31], s60 offen offset:3168 nt lds
    s_add_u32 m0, s54, 4224
    s_waitcnt vmcnt(11)
    buffer_load_dwordx4 v28, s[28:31], s61 offen offset:0 nt lds
    s_waitcnt vmcnt(11)
    buffer_load_dwordx4 v29, s[28:31], s61 offen offset:1056 nt lds
    s_waitcnt vmcnt(11)
    buffer_load_dwordx4 v30, s[28:31], s61 offen offset:2112 nt lds
    s_waitcnt vmcnt(11)
    buffer_load_dwordx4 v31, s[28:31], s61 offen offset:3168 nt lds
    s_add_u32 m0, s54, 8448
    s_waitcnt vmcnt(11)
    buffer_load_dwordx4 v28, s[28:31], s62 offen offset:0 nt lds
    s_waitcnt vmcnt(11)
    buffer_load_dwordx4 v29, s[28:31], s62 offen offset:1056 nt lds
    s_waitcnt vmcnt(11)
    buffer_load_dwordx4 v30, s[28:31], s62 offen offset:2112 nt lds
    s_waitcnt vmcnt(11)
    s_lshl1_add_u32 s52, s50, 0
    v_mov_b32 v37, s52
    ds_write_b32 v36, v37 offset:16
    ds_read_b128 v[32:35], v36
    buffer_load_dwordx4 v31, s[28:31], s62 offen offset:3168 nt lds
    s_add_u32 m0, s54, 12672
    s_waitcnt vmcnt(11)
    buffer_load_dwordx4 v28, s[28:31], s63 offen offset:0 nt lds
    s_waitcnt vmcnt(11)
    buffer_load_dwordx4 v29, s[28:31], s63 offen offset:1056 nt lds
    s_waitcnt vmcnt(11)
    buffer_load_dwordx4 v30, s[28:31], s63 offen offset:2112 nt lds
    s_waitcnt vmcnt(11)
    buffer_load_dwordx4 v31, s[28:31], s63 offen offset:3168 nt lds
    s_add_u32 s50, s50, 1
    s_mov_b64 s[60:61], s[56:57]
    s_mov_b64 s[62:63], s[58:59]
    s_cmp_eq_u32 s50, 2
    s_cbranch_scc0 L_tab12
L_tw12:
    ds_read_b128 v[40:43], v36 offset:32
    ds_read_b128 v[20:23], v39
    s_waitcnt lgkmcnt(0)
    v_min3_u32 v40, v40, v41, v42
    v_min_u32 v40, v40, v43
    s_nop 0
    v_readfirstlane_b32 s47, v40
    s_nop 0
    s_cmp_eq_u32 s47, 0
    s_cbranch_scc1 L_tw12
L_tab12:
    v_readlane_b32 s56, v20, s50
    v_readlane_b32 s57, v21, s50
    v_readlane_b32 s58, v22, s50
    v_readlane_b32 s59, v23, s50
    s_add_u32 s53, s53, 17408
    s_cmp_ge_u32 s53, 69632
    s_cselect_b32 s53, 0, s53
    s_add_u32 s54, s54, 16896
    s_cmp_ge_u32 s54, 137216
    s_cselect_b32 s54, 69632, s54
    s_cmp_lt_u32 s50, s51
    s_cbranch_scc1 L_loop12
L_tail12:
    s_sub_i32 s48, s50, 3
    s_branch L_fchkb12
L_fspinb12:
    ds_read_b128 v[32:35], v36
L_fchkb12:
    s_waitcnt lgkmcnt(0)
    v_min_u32 v32, v32, v33
    v_min3_u32 v32, v32, v34, v35
    s_nop 0
    v_readfirstlane_b32 s47, v32
    s_nop 0
    s_cmp_ge_i32 s47, s48
    s_cbranch_scc0 L_fspinb12
    s_add_u32 m0, s54, 0
    s_waitcnt vmcnt(11)
    buffer_load_dwordx4 v28, s[28:31], s60 offen offset:0 nt lds
    s_waitcnt vmcnt(11)
    buffer_load_dwordx4 v29, s[28:31], s60 offen offset:1056 nt lds
    s_waitcnt vmcnt(11)
    buffer_load_dwordx4 v30, s[28:31], s60 offen offset:2112 nt lds
    s_waitcnt vmcnt(11)
    buffer_load_dwordx4 v31, s[28:31], s60 offen offset:3168 nt lds
    s_add_u32 m0, s54, 4224
    s_waitcnt vmcnt(11)
    buffer_load_dwordx4 v28, s[28:31], s61 offen offset:0 nt lds
    s_waitcnt vmcnt(11)
    buffer_load_dwordx4 v29, s[28:31], s61 offen offset:1056 nt lds
    s_waitcnt vmcnt(11)
    buffer_load_dwordx4 v30, s[28:31], s61 offen offset:2112 nt lds
    s_waitcnt vmcnt(11)
    buffer_load_dwordx4 v31, s[28:31], s61 offen offset:3168 nt lds
    s_add_u32 m0, s54, 8448
    s_waitcnt vmcnt(11)
    buffer_load_dwordx4 v28, s[28:31], s62 offen offset:0 nt lds
    s_waitcnt vmcnt(11)
    buffer_load_dwordx4 v29, s[28:31], s62 offen offset:1056 nt lds
    s_waitcnt vmcnt(11)
    buffer_load_dwordx4 v30, s[28:31], s62 offen offset:2112 nt lds
    s_waitcnt vmcnt(11)
    s_lshl1_add_u32 s52, s50, -1
    v_mov_b32 v37, s52
    ds_write_b32 v36, v37 offset:16
    buffer_load_dwordx4 v31, s[28:31], s62 offen offset:3168 nt lds
    s_add_u32 m0, s54, 12672
    s_waitcnt vmcnt(11)
    buffer_load_dwordx4 v28, s[28:31], s63 offen offset:0 nt lds
    s_waitcnt vmcnt(11)
    buffer_load_dwordx4 v29, s[28:31], s63 offen offset:1056 nt lds
    s_waitcnt vmcnt(11)
    buffer_load_dwordx4 v30, s[28:31], s63 offen offset:2112 nt lds
    s_waitcnt vmcnt(11)
    buffer_load_dwordx4 v31, s[28:31], s63 offen offset:3168 nt lds
    s_branch L_drain
L_pro13:
    s_mov_b32 m0, 8704
    s_nop 0
    buffer_load_dwordx4 v24, s[24:27], s62 offen offset:0 nt lds
    buffer_load_dwordx4 v25, s[24:27], s62 offen offset:1088 nt lds
    buffer_load_dwordx4 v26, s[24:27], s62 offen offset:2176 nt lds
    buffer_load_dwordx4 v27, s[24:27], s62 offen offset:3264 nt lds
    s_mov_b32 m0, 13056
    s_nop 0
    buffer_load_dwordx4 v24, s[24:27], s63 offen offset:0 nt lds
    s_waitcnt vmcnt(12)
    buffer_load_dwordx4 v25, s[24:27], s63 offen offset:1088 nt lds
    s_waitcnt vmcnt(12)
    buffer_load_dwordx4 v26, s[24:27], s63 offen offset:2176 nt lds
    s_waitcnt vmcnt(12)
    buffer_load_dwordx4 v27, s[24:27], s63 offen offset:3264 nt lds
    s_mov_b32 s53, 17408
    s_cmp_ge_u32 s50, s51
    s_cbranch_scc1 L_tail13
L_loop13:
    s_sub_i32 s48, s50, 3
    s_branch L_fchka13
L_fspina13:
    ds_read_b128 v[32:35], v36
L_fchka13:
    s_waitcnt lgkmcnt(0)
    v_min_u32 v32, v32, v33
    v_min3_u32 v32, v32, v34, v35
    s_nop 0
    v_readfirstlane_b32 s47, v32
    s_nop 0
    s_cmp_ge_i32 s47, s48
    s_cbranch_scc0 L_fspina13
    s_add_u32 m0, s53, 0
    s_waitcnt vmcnt(12)
    buffer_load_dwordx4 v24, s[24:27], s56 offen offset:0 nt lds
    s_waitcnt vmcnt(12)
    buffer_load_dwordx4 v25, s[24:27], s56 offen offset:1088 nt lds
    s_waitcnt vmcnt(12)
    buffer_load_dwordx4 v26, s[24:27], s56 offen offset:2176 nt lds
    s_waitcnt vmcnt(12)
    buffer_load_dwordx4 v27, s[24:27], s56 offen offset:3264 nt lds
    s_add_u32 m0, s53, 4352
    s_waitcnt vmcnt(12)
    buffer_load_dwordx4 v24, s[24:27], s57 offen offset:0 nt lds
    s_waitcnt vmcnt(12)
    buffer_load_dwordx4 v25, s[24:27], s57 offen offset:1088 nt lds
    s_waitcnt vmcnt(12)
    buffer_load_dwordx4 v26, s[24:27], s57 offen offset:2176 nt lds
    s_waitcnt vmcnt(12)
    buffer_load_dwordx4 v27, s[24:27], s57 offen offset:3264 nt lds
    s_add_u32 m0, s53, 8704
    s_waitcnt vmcnt(12)
    buffer_load_dwordx4 v24, s[24:27], s58 offen offset:0 nt lds
    s_waitcnt vmcnt(12)
    buffer_load_dwordx4 v25, s[24:27], s58 offen offset:1088 nt lds
    s_waitcnt vmcnt(12)
    buffer_load_dwordx4 v26, s[24:27], s58 offen offset:2176 nt lds
    s_waitcnt vmcnt(12)
    buffer_load_dwordx4 v27, s[24:27], s58 offen offset:3264 nt lds
    s_add_u32 m0, s53, 13056
    s_waitcnt vmcnt(12)
    s_lshl1_add_u32 s52, s50, -1
    v_mov_b32 v37, s52
    ds_write_b32 v36, v37 offset:16
    buffer_load_dwordx4 v24, s[24:27], s59 offen offset:0 nt lds
    s_waitcnt vmcnt(12)
    buffer_load_dwordx4 v25, s[24:27], s59 offen offset:1088 nt lds
    s_waitcnt vmcnt(12)
    buffer_load_dwordx4 v26, s[24:27], s59 offen offset:2176 nt lds
    s_waitcnt vmcnt(12)
    buffer_load_dwordx4 v27, s[24:27], s59 offen offset:3264 nt lds
    s_add_u32 m0, s54, 0
    s_waitcnt vmcnt(12)
    buffer_load_dwordx4 v28, s[28:31], s60 offen offset:0 nt lds
    s_waitcnt vmcnt(12)
    buffer_load_dwordx4 v29, s[28:31], s60 offen offset:1056 nt lds
    s_waitcnt vmcnt(12)
    buffer_load_dwordx4 v30, s[28:31], s60 offen offset:2112 nt lds
    s_waitcnt vmcnt(12)
    buffer_load_dwordx4 v31, s[28:31], s60 offen offset:3168 nt lds
    s_add_u32 m0, s54, 4224
    s_waitcnt vmcnt(12)
    buffer_load_dwordx4 v28, s[28:31], s61 offen offset:0 nt lds
    s_waitcnt vmcnt(12)
    buffer_load_dwordx4 v29, s[28:31], s61 offen offset:1056 nt lds
    s_waitcnt vmcnt(12)
    buffer_load_dwordx4 v30, s[28:31], s61 offen offset:2112 nt lds
    s_waitcnt vmcnt(12)
    buffer_load_dwordx4 v31, s[28:31], s61 offen offset:3168 nt lds
    s_add_u32 m0, s54, 8448
    s_waitcnt vmcnt(12)
    buffer_load_dwordx4 v28, s[28:31], s62 offen offset:0 nt lds
    s_waitcnt vmcnt(12)
    buffer_load_dwordx4 v29, s[28:31], s62 offen offset:1056 nt lds
    s_waitcnt vmcnt(12)
    buffer_load_dwordx4 v30, s[28:31], s62 offen offset:2112 nt lds
    s_waitcnt vmcnt(12)
    ds_read_b128 v[32:35], v36
    buffer_load_dwordx4 v31, s[28:31], s62 offen offset:3168 nt lds
    s_add_u32 m0, s54, 12672
    s_waitcnt vmcnt(12)
    s_lshl1_add_u32 s52, s50, 0
    v_mov_b32 v37, s52
    ds_write_b32 v36, v37 offset:16
    buffer_load_dwordx4 v28, s[28:31], s63 offen offset:0 nt lds
    s_waitcnt vmcnt(12)
    buffer_load_dwordx4 v29, s[28:31], s63 offen offset:1056 nt lds
    s_waitcnt vmcnt(12)
    buffer_load_dwordx4 v30, s[28:31], s63 offen offset:2112 nt lds
    s_waitcnt vmcnt(12)
    buffer_load_dwordx4 v31, s[28:31], s63 offen offset:3168 nt lds
    s_add_u32 s50, s50, 1
    s_mov_b64 s[60:61], s[56:57]
    s_mov_b64 s[62:63], s[58:59]
    s_cmp_eq_u32 s50, 2
    s_cbranch_scc0 L_tab13
L_tw13:
    ds_read_b128 v[40:43], v36 offset:32
    ds_read_b128 v[20:23], v39
    s_waitcnt lgkmcnt(0)
    v_min3_u32 v40, v40, v41, v42
    v_min_u32 v40, v40, v43
    s_nop 0
    v_readfirstlane_b32 s47, v40
    s_nop 0
    s_cmp_eq_u32 s47, 0
    s_cbranch_scc1 L_tw13
L_tab13:
    v_readlane_b32 s56, v20, s50
    v_readlane_b32 s57, v21, s50
    v_readlane_b32 s58, v22, s50
    v_readlane_b32 s59, v23, s50
    s_add_u32 s53, s53, 17408
    s_cmp_ge_u32 s53, 69632
    s_cselect_b32 s53, 0, s53
    s_add_u32 s54, s54, 16896
    s_cmp_ge_u32 s54, 137216
    s_cselect_b32 s54, 69632, s54
    s_cmp_lt_u32 s50, s51
    s_cbranch_scc1 L_loop13
L_tail13:
    s_sub_i32 s48, s50, 3
    s_branch L_fchkb13
L_fspinb13:
    ds_read_b128 v[32:35], v36
L_fchkb13:
    s_waitcnt lgkmcnt(0)
    v_min_u32 v32, v32, v33
    v_min3_u32 v32, v32, v34, v35
    s_nop 0
    v_readfirstlane_b32 s47, v32
    s_nop 0
    s_cmp_ge_i32 s47, s48
    s_cbranch_scc0 L_fspinb13
    s_add_u32 m0, s54, 0
    s_waitcnt vmcnt(12)
    buffer_load_dwordx4 v28, s[28:31], s60 offen offset:0 nt lds
    s_waitcnt vmcnt(12)
    buffer_load_dwordx4 v29, s[28:31], s60 offen offset:1056 nt lds
    s_waitcnt vmcnt(12)
    buffer_load_dwordx4 v30, s[28:31], s60 offen offset:2112 nt lds
    s_waitcnt vmcnt(12)
    buffer_load_dwordx4 v31, s[28:31], s60 offen offset:3168 nt lds
    s_add_u32 m0, s54, 4224
    s_waitcnt vmcnt(12)
    buffer_load_dwordx4 v28, s[28:31], s61 offen offset:0 nt lds
    s_waitcnt vmcnt(12)
    buffer_load_dwordx4 v29, s[28:31], s61 offen offset:1056 nt lds
    s_waitcnt vmcnt(12)
    buffer_load_dwordx4 v30, s[28:31], s61 offen offset:2112 nt lds
    s_waitcnt vmcnt(12)
    buffer_load_dwordx4 v31, s[28:31], s61 offen offset:3168 nt lds
    s_add_u32 m0, s54, 8448
    s_waitcnt vmcnt(12)
    buffer_load_dwordx4 v28, s[28:31], s62 offen offset:0 nt lds
    s_waitcnt vmcnt(12)
    buffer_load_dwordx4 v29, s[28:31], s62 offen offset:1056 nt lds
    s_waitcnt vmcnt(12)
    buffer_load_dwordx4 v30, s[28:31], s62 offen offset:2112 nt lds
    s_waitcnt vmcnt(12)
    buffer_load_dwordx4 v31, s[28:31], s62 offen offset:3168 nt lds
    s_add_u32 m0, s54, 12672
    s_waitcnt vmcnt(12)
    s_lshl1_add_u32 s52, s50, -1
    v_mov_b32 v37, s52
    ds_write_b32 v36, v37 offset:16
    buffer_load_dwordx4 v28, s[28:31], s63 offen offset:0 nt lds
    s_waitcnt vmcnt(12)
    buffer_load_dwordx4 v29, s[28:31], s63 offen offset:1056 nt lds
    s_waitcnt vmcnt(12)
    buffer_load_dwordx4 v30, s[28:31], s63 offen offset:2112 nt lds
    s_waitcnt vmcnt(12)
    buffer_load_dwordx4 v31, s[28:31], s63 offen offset:3168 nt lds
    s_branch L_drain
L_pro14:
    s_mov_b32 m0, 8704
    s_nop 0
    buffer_load_dwordx4 v24, s[24:27], s62 offen offset:0 nt lds
    buffer_load_dwordx4 v25, s[24:27], s62 offen offset:1088 nt lds
    buffer_load_dwordx4 v26, s[24:27], s62 offen offset:2176 nt lds
    buffer_load_dwordx4 v27, s[24:27], s62 offen offset:3264 nt lds
    s_mov_b32 m0, 13056
    s_nop 0
    buffer_load_dwordx4 v24, s[24:27], s63 offen offset:0 nt lds
    buffer_load_dwordx4 v25, s[24:27], s63 offen offset:1088 nt lds
    s_waitcnt vmcnt(13)
    buffer_load_dwordx4 v26, s[24:27], s63 offen offset:2176 nt lds
    s_waitcnt vmcnt(13)
    buffer_load_dwordx4 v27, s[24:27], s63 offen offset:3264 nt lds
    s_mov_b32 s53, 17408
    s_cmp_ge_u32 s50, s51
    s_cbranch_scc1 L_tail14
L_loop14:
    s_sub_i32 s48, s50, 3
    s_branch L_fchka14
L_fspina14:
    ds_read_b128 v[32:35], v36
L_fchka14:
    s_waitcnt lgkmcnt(0)
    v_min_u32 v32, v32, v33
    v_min3_u32 v32, v32, v34, v35
    s_nop 0
    v_readfirstlane_b32 s47, v32
    s_nop 0
    s_cmp_ge_i32 s47, s48
    s_cbranch_scc0 L_fspina14
    s_add_u32 m0, s53, 0
    s_waitcnt vmcnt(13)
    buffer_load_dwordx4 v24, s[24:27], s56 offen offset:0 nt lds
    s_waitcnt vmcnt(13)
    buffer_load_dwordx4 v25, s[24:27], s56 offen offset:1088 nt lds
    s_waitcnt vmcnt(13)
    buffer_load_dwordx4 v26, s[24:27], s56 offen offset:2176 nt lds
    s_waitcnt vmcnt(13)
    buffer_load_dwordx4 v27, s[24:27], s56 offen offset:3264 nt lds
    s_add_u32 m0, s53, 4352
    s_waitcnt vmcnt(13)
    buffer_load_dwordx4 v24, s[24:27], s57 offen offset:0 nt lds
    s_waitcnt vmcnt(13)
    buffer_load_dwordx4 v25, s[24:27], s57 offen offset:1088 nt lds
    s_waitcnt vmcnt(13)
    buffer_load_dwordx4 v26, s[24:27], s57 offen offset:2176 nt lds
    s_waitcnt vmcnt(13)
    buffer_load_dwordx4 v27, s[24:27], s57 offen offset:3264 nt lds
    s_add_u32 m0, s53, 8704
    s_waitcnt vmcnt(13)
    buffer_load_dwordx4 v24, s[24:27], s58 offen offset:0 nt lds
    s_waitcnt vmcnt(13)
    buffer_load_dwordx4 v25, s[24:27], s58 offen offset:1088 nt lds
    s_waitcnt vmcnt(13)
    buffer_load_dwordx4 v26, s[24:27], s58 offen offset:2176 nt lds
    s_waitcnt vmcnt(13)
    buffer_load_dwordx4 v27, s[24:27], s58 offen offset:3264 nt lds
    s_add_u32 m0, s53, 13056
    s_waitcnt vmcnt(13)
    buffer_load_dwordx4 v24, s[24:27], s59 offen offset:0 nt lds
    s_waitcnt vmcnt(13)
    s_lshl1_add_u32 s52, s50, -1
    v_mov_b32 v37, s52
    ds_write_b32 v36, v37 offset:16
    buffer_load_dwordx4 v25, s[24:27], s59 offen offset:1088 nt lds
    s_waitcnt vmcnt(13)
    buffer_load_dwordx4 v26, s[24:27], s59 offen offset:2176 nt lds
    s_waitcnt vmcnt(13)
    buffer_load_dwordx4 v27, s[24:27], s59 offen offset:3264 nt lds
    s_add_u32 m0, s54, 0
    s_waitcnt vmcnt(13)
    buffer_load_dwordx4 v28, s[28:31], s60 offen offset:0 nt lds
    s_waitcnt vmcnt(13)
    buffer_load_dwordx4 v29, s[28:31], s60 offen offset:1056 nt lds
    s_waitcnt vmcnt(13)
    buffer_load_dwordx4 v30, s[28:31], s60 offen offset:2112 nt lds
    s_waitcnt vmcnt(13)
    buffer_load_dwordx4 v31, s[28:31], s60 offen offset:3168 nt lds
    s_add_u32 m0, s54, 4224
    s_waitcnt vmcnt(13)
    buffer_load_dwordx4 v28, s[28:31], s61 offen offset:0 nt lds
    s_waitcnt vmcnt(13)
    buffer_load_dwordx4 v29, s[28:31], s61 offen offset:1056 nt lds
    s_waitcnt vmcnt(13)
    buffer_load_dwordx4 v30, s[28:31], s61 offen offset:2112 nt lds
    s_waitcnt vmcnt(13)
    buffer_load_dwordx4 v31, s[28:31], s61 offen offset:3168 nt lds
    s_add_u32 m0, s54, 8448
    s_waitcnt vmcnt(13)
    buffer_load_dwordx4 v28, s[28:31], s62 offen offset:0 nt lds
    s_waitcnt vmcnt(13)
    buffer_load_dwordx4 v29, s[28:31], s62 offen offset:1056 nt lds
    s_waitcnt vmcnt(13)
    buffer_load_dwordx4 v30, s[28:31], s62 offen offset:2112 nt lds
    s_waitcnt vmcnt(13)
    ds_read_b128 v[32:35], v36
    buffer_load_dwordx4 v31, s[28:31], s62 offen offset:3168 nt lds
    s_add_u32 m0, s54, 12672
    s_waitcnt vmcnt(13)
    buffer_load_dwordx4 v28, s[28:31], s63 offen offset:0 nt lds
    s_waitcnt vmcnt(13)
    s_lshl1_add_u32 s52, s50, 0
    v_mov_b32 v37, s52
    ds_write_b32 v36, v37 offset:16
    buffer_load_dwordx4 v29, s[28:31], s63 offen offset:1056 nt lds
    s_waitcnt vmcnt(13)
    buffer_load_dwordx4 v30, s[28:31], s63 offen offset:2112 nt lds
    s_waitcnt vmcnt(13)
    buffer_load_dwordx4 v31, s[28:31], s63 offen offset:3168 nt lds
    s_add_u32 s50, s50, 1
    s_mov_b64 s[60:61], s[56:57]
    s_mov_b64 s[62:63], s[58:59]
    s_cmp_eq_u32 s50, 2
    s_cbranch_scc0 L_tab14
L_tw14:
    ds_read_b128 v[40:43], v36 offset:32
    ds_read_b128 v[20:23], v39
    s_waitcnt lgkmcnt(0)
    v_min3_u32 v40, v40, v41, v42
    v_min_u32 v40, v40, v43
    s_nop 0
    v_readfirstlane_b32 s47, v40
    s_nop 0
    s_cmp_eq_u32 s47, 0
    s_cbranch_scc1 L_tw14
L_tab14:
    v_readlane_b32 s56, v20, s50
    v_readlane_b32 s57, v21, s50
    v_readlane_b32 s58, v22, s50
    v_readlane_b32 s59, v23, s50
    s_add_u32 s53, s53, 17408
    s_cmp_ge_u32 s53, 69632
    s_cselect_b32 s53, 0, s53
    s_add_u32 s54, s54, 16896
    s_cmp_ge_u32 s54, 137216
    s_cselect_b32 s54, 69632, s54
    s_cmp_lt_u32 s50, s51
    s_cbranch_scc1 L_loop14
L_tail14:
    s_sub_i32 s48, s50, 3
    s_branch L_fchkb14
L_fspinb14:
    ds_read_b128 v[32:35], v36
L_fchkb14:
    s_waitcnt lgkmcnt(0)
    v_min_u32 v32, v32, v33
    v_min3_u32 v32, v32, v34, v35
    s_nop 0
    v_readfirstlane_b32 s47, v32
    s_nop 0
    s_cmp_ge_i32 s47, s48
    s_cbranch_scc0 L_fspinb14
    s_add_u32 m0, s54, 0
    s_waitcnt vmcnt(13)
    buffer_load_dwordx4 v28, s[28:31], s60 offen offset:0 nt lds
    s_waitcnt vmcnt(13)
    buffer_load_dwordx4 v29, s[28:31], s60 offen offset:1056 nt lds
    s_waitcnt vmcnt(13)
    buffer_load_dwordx4 v30, s[28:31], s60 offen offset:2112 nt lds
    s_waitcnt vmcnt(13)
    buffer_load_dwordx4 v31, s[28:31], s60 offen offset:3168 nt lds
    s_add_u32 m0, s54, 4224
    s_waitcnt vmcnt(13)
    buffer_load_dwordx4 v28, s[28:31], s61 offen offset:0 nt lds
    s_waitcnt vmcnt(13)
    buffer_load_dwordx4 v29, s[28:31], s61 offen offset:1056 nt lds
    s_waitcnt vmcnt(13)
    buffer_load_dwordx4 v30, s[28:31], s61 offen offset:2112 nt lds
    s_waitcnt vmcnt(13)
    buffer_load_dwordx4 v31, s[28:31], s61 offen offset:3168 nt lds
    s_add_u32 m0, s54, 8448
    s_waitcnt vmcnt(13)
    buffer_load_dwordx4 v28, s[28:31], s62 offen offset:0 nt lds
    s_waitcnt vmcnt(13)
    buffer_load_dwordx4 v29, s[28:31], s62 offen offset:1056 nt lds
    s_waitcnt vmcnt(13)
    buffer_load_dwordx4 v30, s[28:31], s62 offen offset:2112 nt lds
    s_waitcnt vmcnt(13)
    buffer_load_dwordx4 v31, s[28:31], s62 offen offset:3168 nt lds
    s_add_u32 m0, s54, 12672
    s_waitcnt vmcnt(13)
    buffer_load_dwordx4 v28, s[28:31], s63 offen offset:0 nt lds
    s_waitcnt vmcnt(13)
    s_lshl1_add_u32 s52, s50, -1
    v_mov_b32 v37, s52
    ds_write_b32 v36, v37 offset:16
    buffer_load_dwordx4 v29, s[28:31], s63 offen offset:1056 nt lds
    s_waitcnt vmcnt(13)
    buffer_load_dwordx4 v30, s[28:31], s63 offen offset:2112 nt lds
    s_waitcnt vmcnt(13)
    buffer_load_dwordx4 v31, s[28:31], s63 offen offset:3168 nt lds
    s_branch L_drain
L_pro15:
    s_mov_b32 m0, 8704
    s_nop 0
    buffer_load_dwordx4 v24, s[24:27], s62 offen offset:0 nt lds
    buffer_load_dwordx4 v25, s[24:27], s62 offen offset:1088 nt lds
    buffer_load_dwordx4 v26, s[24:27], s62 offen offset:2176 nt lds
    buffer_load_dwordx4 v27, s[24:27], s62 offen offset:3264 nt lds
    s_mov_b32 m0, 13056
    s_nop 0
    buffer_load_dwordx4 v24, s[24:27], s63 offen offset:0 nt lds
    buffer_load_dwordx4 v25, s[24:27], s63 offen offset:1088 nt lds
    buffer_load_dwordx4 v26, s[24:27], s63 offen offset:2176 nt lds
    s_waitcnt vmcnt(14)
    buffer_load_dwordx4 v27, s[24:27], s63 offen offset:3264 nt lds
    s_mov_b32 s53, 17408
    s_cmp_ge_u32 s50, s51
    s_cbranch_scc1 L_tail15
L_loop15:
    s_sub_i32 s48, s50, 3
    s_branch L_fchka15
L_fspina15:
    ds_read_b128 v[32:35], v36
L_fchka15:
    s_waitcnt lgkmcnt(0)
    v_min_u32 v32, v32, v33
    v_min3_u32 v32, v32, v34, v35
    s_nop 0
    v_readfirstlane_b32 s47, v32
    s_nop 0
    s_cmp_ge_i32 s47, s48
    s_cbranch_scc0 L_fspina15
    s_add_u32 m0, s53, 0
    s_waitcnt vmcnt(14)
    buffer_load_dwordx4 v24, s[24:27], s56 offen offset:0 nt lds
    s_waitcnt vmcnt(14)
    buffer_load_dwordx4 v25, s[24:27], s56 offen offset:1088 nt lds
    s_waitcnt vmcnt(14)
    buffer_load_dwordx4 v26, s[24:27], s56 offen offset:2176 nt lds
    s_waitcnt vmcnt(14)
    buffer_load_dwordx4 v27, s[24:27], s56 offen offset:3264 nt lds
    s_add_u32 m0, s53, 4352
    s_waitcnt vmcnt(14)
    buffer_load_dwordx4 v24, s[24:27], s57 offen offset:0 nt lds
    s_waitcnt vmcnt(14)
    buffer_load_dwordx4 v25, s[24:27], s57 offen offset:1088 nt lds
    s_waitcnt vmcnt(14)
    buffer_load_dwordx4 v26, s[24:27], s57 offen offset:2176 nt lds
    s_waitcnt vmcnt(14)
    buffer_load_dwordx4 v27, s[24:27], s57 offen offset:3264 nt lds
    s_add_u32 m0, s53, 8704
    s_waitcnt vmcnt(14)
    buffer_load_dwordx4 v24, s[24:27], s58 offen offset:0 nt lds
    s_waitcnt vmcnt(14)
    buffer_load_dwordx4 v25, s[24:27], s58 offen offset:1088 nt lds
    s_waitcnt vmcnt(14)
    buffer_load_dwordx4 v26, s[24:27], s58 offen offset:2176 nt lds
    s_waitcnt vmcnt(14)
    buffer_load_dwordx4 v27, s[24:27], s58 offen offset:3264 nt lds
    s_add_u32 m0, s53, 13056
    s_waitcnt vmcnt(14)
    buffer_load_dwordx4 v24, s[24:27], s59 offen offset:0 nt lds
    s_waitcnt vmcnt(14)
    buffer_load_dwordx4 v25, s[24:27], s59 offen offset:1088 nt lds
    s_waitcnt vmcnt(14)
    s_lshl1_add_u32 s52, s50, -1
    v_mov_b32 v37, s52
    ds_write_b32 v36, v37 offset:16
    buffer_load_dwordx4 v26, s[24:27], s59 offen offset:2176 nt lds
    s_waitcnt vmcnt(14)
    buffer_load_dwordx4 v27, s[24:27], s59 offen offset:3264 nt lds
    s_add_u32 m0, s54, 0
    s_waitcnt vmcnt(14)
    buffer_load_dwordx4 v28, s[28:31], s60 offen offset:0 nt lds
    s_waitcnt vmcnt(14)
    buffer_load_dwordx4 v29, s[28:31], s60 offen offset:1056 nt lds
    s_waitcnt vmcnt(14)
    buffer_load_dwordx4 v30, s[28:31], s60 offen offset:2112 nt lds
    s_waitcnt vmcnt(14)
    buffer_load_dwordx4 v31, s[28:31], s60 offen offset:3168 nt lds
    s_add_u32 m0, s54, 4224
    s_waitcnt vmcnt(14)
    buffer_load_dwordx4 v28, s[28:31], s61 offen offset:0 nt lds
    s_waitcnt vmcnt(14)
    buffer_load_dwordx4 v29, s[28:31], s61 offen offset:1056 nt lds
    s_waitcnt vmcnt(14)
    buffer_load_dwordx4 v30, s[28:31], s61 offen offset:2112 nt lds
    s_waitcnt vmcnt(14)
    buffer_load_dwordx4 v31, s[28:31], s61 offen offset:3168 nt lds
    s_add_u32 m0, s54, 8448
    s_waitcnt vmcnt(14)
    buffer_load_dwordx4 v28, s[28:31], s62 offen offset:0 nt lds
    s_waitcnt vmcnt(14)
    buffer_load_dwordx4 v29, s[28:31], s62 offen offset:1056 nt lds
    s_waitcnt vmcnt(14)
    buffer_load_dwordx4 v30, s[28:31], s62 offen offset:2112 nt lds
    s_waitcnt vmcnt(14)
    ds_read_b128 v[32:35], v36
    buffer_load_dwordx4 v31, s[28:31], s62 offen offset:3168 nt lds
    s_add_u32 m0, s54, 12672
    s_waitcnt vmcnt(14)
    buffer_load_dwordx4 v28, s[28:31], s63 offen offset:0 nt lds
    s_waitcnt vmcnt(14)
    buffer_load_dwordx4 v29, s[28:31], s63 offen offset:1056 nt lds
    s_waitcnt vmcnt(14)
    s_lshl1_add_u32 s52, s50, 0
    v_mov_b32 v37, s52
    ds_write_b32 v36, v37 offset:16
    buffer_load_dwordx4 v30, s[28:31], s63 offen offset:2112 nt lds
    s_waitcnt vmcnt(14)
    buffer_load_dwordx4 v31, s[28:31], s63 offen offset:3168 nt lds
    s_add_u32 s50, s50, 1
    s_mov_b64 s[60:61], s[56:57]
    s_mov_b64 s[62:63], s[58:59]
    s_cmp_eq_u32 s50, 2
    s_cbranch_scc0 L_tab15
L_tw15:
    ds_read_b128 v[40:43], v36 offset:32
    ds_read_b128 v[20:23], v39
    s_waitcnt lgkmcnt(0)
    v_min3_u32 v40, v40, v41, v42
    v_min_u32 v40, v40, v43
    s_nop 0
    v_readfirstlane_b32 s47, v40
    s_nop 0
    s_cmp_eq_u32 s47, 0
    s_cbranch_scc1 L_tw15
L_tab15:
    v_readlane_b32 s56, v20, s50
    v_readlane_b32 s57, v21, s50
    v_readlane_b32 s58, v22, s50
    v_readlane_b32 s59, v23, s50
    s_add_u32 s53, s53, 17408
    s_cmp_ge_u32 s53, 69632
    s_cselect_b32 s53, 0, s53
    s_add_u32 s54, s54, 16896
    s_cmp_ge_u32 s54, 137216
    s_cselect_b32 s54, 69632, s54
    s_cmp_lt_u32 s50, s51
    s_cbranch_scc1 L_loop15
L_tail15:
    s_sub_i32 s48, s50, 3
    s_branch L_fchkb15
L_fspinb15:
    ds_read_b128 v[32:35], v36
L_fchkb15:
    s_waitcnt lgkmcnt(0)
    v_min_u32 v32, v32, v33
    v_min3_u32 v32, v32, v34, v35
    s_nop 0
    v_readfirstlane_b32 s47, v32
    s_nop 0
    s_cmp_ge_i32 s47, s48
    s_cbranch_scc0 L_fspinb15
    s_add_u32 m0, s54, 0
    s_waitcnt vmcnt(14)
    buffer_load_dwordx4 v28, s[28:31], s60 offen offset:0 nt lds
    s_waitcnt vmcnt(14)
    buffer_load_dwordx4 v29, s[28:31], s60 offen offset:1056 nt lds
    s_waitcnt vmcnt(14)
    buffer_load_dwordx4 v30, s[28:31], s60 offen offset:2112 nt lds
    s_waitcnt vmcnt(14)
    buffer_load_dwordx4 v31, s[28:31], s60 offen offset:3168 nt lds
    s_add_u32 m0, s54, 4224
    s_waitcnt vmcnt(14)
    buffer_load_dwordx4 v28, s[28:31], s61 offen offset:0 nt lds
    s_waitcnt vmcnt(14)
    buffer_load_dwordx4 v29, s[28:31], s61 offen offset:1056 nt lds
    s_waitcnt vmcnt(14)
    buffer_load_dwordx4 v30, s[28:31], s61 offen offset:2112 nt lds
    s_waitcnt vmcnt(14)
    buffer_load_dwordx4 v31, s[28:31], s61 offen offset:3168 nt lds
    s_add_u32 m0, s54, 8448
    s_waitcnt vmcnt(14)
    buffer_load_dwordx4 v28, s[28:31], s62 offen offset:0 nt lds
    s_waitcnt vmcnt(14)
    buffer_load_dwordx4 v29, s[28:31], s62 offen offset:1056 nt lds
    s_waitcnt vmcnt(14)
    buffer_load_dwordx4 v30, s[28:31], s62 offen offset:2112 nt lds
    s_waitcnt vmcnt(14)
    buffer_load_dwordx4 v31, s[28:31], s62 offen offset:3168 nt lds
    s_add_u32 m0, s54, 12672
    s_waitcnt vmcnt(14)
    buffer_load_dwordx4 v28, s[28:31], s63 offen offset:0 nt lds
    s_waitcnt vmcnt(14)
    buffer_load_dwordx4 v29, s[28:31], s63 offen offset:1056 nt lds
    s_waitcnt vmcnt(14)
    s_lshl1_add_u32 s52, s50, -1
    v_mov_b32 v37, s52
    ds_write_b32 v36, v37 offset:16
    buffer_load_dwordx4 v30, s[28:31], s63 offen offset:2112 nt lds
    s_waitcnt vmcnt(14)
    buffer_load_dwordx4 v31, s[28:31], s63 offen offset:3168 nt lds
    s_branch L_drain
L_pro16:
    s_mov_b32 m0, 8704
    s_nop 0
    buffer_load_dwordx4 v24, s[24:27], s62 offen offset:0 nt lds
    buffer_load_dwordx4 v25, s[24:27], s62 offen offset:1088 nt lds
    buffer_load_dwordx4 v26, s[24:27], s62 offen offset:2176 nt lds
    buffer_load_dwordx4 v27, s[24:27], s62 offen offset:3264 nt lds
    s_mov_b32 m0, 13056
    s_nop 0
    buffer_load_dwordx4 v24, s[24:27], s63 offen offset:0 nt lds
    buffer_load_dwordx4 v25, s[24:27], s63 offen offset:1088 nt lds
    buffer_load_dwordx4 v26, s[24:27], s63 offen offset:2176 nt lds
    buffer_load_dwordx4 v27, s[24:27], s63 offen offset:3264 nt lds
    s_mov_b32 s53, 17408
    s_cmp_ge_u32 s50, s51
    s_cbranch_scc1 L_tail16
L_loop16:
    s_sub_i32 s48, s50, 3
    s_branch L_fchka16
L_fspina16:
    ds_read_b128 v[32:35], v36
L_fchka16:
    s_waitcnt lgkmcnt(0)
    v_min_u32 v32, v32, v33
    v_min3_u32 v32, v32, v34, v35
    s_nop 0
    v_readfirstlane_b32 s47, v32
    s_nop 0
    s_cmp_ge_i32 s47, s48
    s_cbranch_scc0 L_fspina16
    s_add_u32 m0, s53, 0
    s_waitcnt vmcnt(15)
    buffer_load_dwordx4 v24, s[24:27], s56 offen offset:0 nt lds
    s_waitcnt vmcnt(15)
    buffer_load_dwordx4 v25, s[24:27], s56 offen offset:1088 nt lds
    s_waitcnt vmcnt(15)
    buffer_load_dwordx4 v26, s[24:27], s56 offen offset:2176 nt lds
    s_waitcnt vmcnt(15)
    buffer_load_dwordx4 v27, s[24:27], s56 offen offset:3264 nt lds
    s_add_u32 m0, s53, 4352
    s_waitcnt vmcnt(15)
    buffer_load_dwordx4 v24, s[24:27], s57 offen offset:0 nt lds
    s_waitcnt vmcnt(15)
    buffer_load_dwordx4 v25, s[24:27], s57 offen offset:1088 nt lds
    s_waitcnt vmcnt(15)
    buffer_load_dwordx4 v26, s[24:27], s57 offen offset:2176 nt lds
    s_waitcnt vmcnt(15)
    buffer_load_dwordx4 v27, s[24:27], s57 offen offset:3264 nt lds
    s_add_u32 m0, s53, 8704
    s_waitcnt vmcnt(15)
    buffer_load_dwordx4 v24, s[24:27], s58 offen offset:0 nt lds
    s_waitcnt vmcnt(15)
    buffer_load_dwordx4 v25, s[24:27], s58 offen offset:1088 nt lds
    s_waitcnt vmcnt(15)
    buffer_load_dwordx4 v26, s[24:27], s58 offen offset:2176 nt lds
    s_waitcnt vmcnt(15)
    buffer_load_dwordx4 v27, s[24:27], s58 offen offset:3264 nt lds
    s_add_u32 m0, s53, 13056
    s_waitcnt vmcnt(15)
    buffer_load_dwordx4 v24, s[24:27], s59 offen offset:0 nt lds
    s_waitcnt vmcnt(15)
    buffer_load_dwordx4 v25, s[24:27], s59 offen offset:1088 nt lds
    s_waitcnt vmcnt(15)
    buffer_load_dwordx4 v26, s[24:27], s59 offen offset:2176 nt lds
    s_waitcnt vmcnt(15)
    s_lshl1_add_u32 s52, s50, -1
    v_mov_b32 v37, s52
    ds_write_b32 v36, v37 offset:16
    buffer_load_dwordx4 v27, s[24:27], s59 offen offset:3264 nt lds
    s_add_u32 m0, s54, 0
    s_waitcnt vmcnt(15)
    buffer_load_dwordx4 v28, s[28:31], s60 offen offset:0 nt lds
    s_waitcnt vmcnt(15)
    buffer_load_dwordx4 v29, s[28:31], s60 offen offset:1056 nt lds
    s_waitcnt vmcnt(15)
    buffer_load_dwordx4 v30, s[28:31], s60 offen offset:2112 nt lds
    s_waitcnt vmcnt(15)
    buffer_load_dwordx4 v31, s[28:31], s60 offen offset:3168 nt lds
    s_add_u32 m0, s54, 4224
    s_waitcnt vmcnt(15)
    buffer_load_dwordx4 v28, s[28:31], s61 offen offset:0 nt lds
    s_waitcnt vmcnt(15)
    buffer_load_dwordx4 v29, s[28:31], s61 offen offset:1056 nt lds
    s_waitcnt vmcnt(15)
    buffer_load_dwordx4 v30, s[28:31], s61 offen offset:2112 nt lds
    s_waitcnt vmcnt(15)
    buffer_load_dwordx4 v31, s[28:31], s61 offen offset:3168 nt lds
    s_add_u32 m0, s54, 8448
    s_waitcnt vmcnt(15)
    buffer_load_dwordx4 v28, s[28:31], s62 offen offset:0 nt lds
    s_waitcnt vmcnt(15)
    buffer_load_dwordx4 v29, s[28:31], s62 offen offset:1056 nt lds
    s_waitcnt vmcnt(15)
    buffer_load_dwordx4 v30, s[28:31], s62 offen offset:2112 nt lds
    s_waitcnt vmcnt(15)
    ds_read_b128 v[32:35], v36
    buffer_load_dwordx4 v31, s[28:31], s62 offen offset:3168 nt lds
    s_add_u32 m0, s54, 12672
    s_waitcnt vmcnt(15)
    buffer_load_dwordx4 v28, s[28:31], s63 offen offset:0 nt lds
    s_waitcnt vmcnt(15)
    buffer_load_dwordx4 v29, s[28:31], s63 offen offset:1056 nt lds
    s_waitcnt vmcnt(15)
    buffer_load_dwordx4 v30, s[28:31], s63 offen offset:2112 nt lds
    s_waitcnt vmcnt(15)
    s_lshl1_add_u32 s52, s50, 0
    v_mov_b32 v37, s52
    ds_write_b32 v36, v37 offset:16
    buffer_load_dwordx4 v31, s[28:31], s63 offen offset:3168 nt lds
    s_add_u32 s50, s50, 1
    s_mov_b64 s[60:61], s[56:57]
    s_mov_b64 s[62:63], s[58:59]
    s_cmp_eq_u32 s50, 2
    s_cbranch_scc0 L_tab16
L_tw16:
    ds_read_b128 v[40:43], v36 offset:32
    ds_read_b128 v[20:23], v39
    s_waitcnt lgkmcnt(0)
    v_min3_u32 v40, v40, v41, v42
    v_min_u32 v40, v40, v43
    s_nop 0
    v_readfirstlane_b32 s47, v40
    s_nop 0
    s_cmp_eq_u32 s47, 0
    s_cbranch_scc1 L_tw16
L_tab16:
    v_readlane_b32 s56, v20, s50
    v_readlane_b32 s57, v21, s50
    v_readlane_b32 s58, v22, s50
    v_readlane_b32 s59, v23, s50
    s_add_u32 s53, s53, 17408
    s_cmp_ge_u32 s53, 69632
    s_cselect_b32 s53, 0, s53
    s_add_u32 s54, s54, 16896
    s_cmp_ge_u32 s54, 137216
    s_cselect_b32 s54, 69632, s54
    s_cmp_lt_u32 s50, s51
    s_cbranch_scc1 L_loop16
L_tail16:
    s_sub_i32 s48, s50, 3
    s_branch L_fchkb16
L_fspinb16:
    ds_read_b128 v[32:35], v36
L_fchkb16:
    s_waitcnt lgkmcnt(0)
    v_min_u32 v32, v32, v33
    v_min3_u32 v32, v32, v34, v35
    s_nop 0
    v_readfirstlane_b32 s47, v32
    s_nop 0
    s_cmp_ge_i32 s47, s48
    s_cbranch_scc0 L_fspinb16
    s_add_u32 m0, s54, 0
    s_waitcnt vmcnt(15)
    buffer_load_dwordx4 v28, s[28:31], s60 offen offset:0 nt lds
    s_waitcnt vmcnt(15)
    buffer_load_dwordx4 v29, s[28:31], s60 offen offset:1056 nt lds
    s_waitcnt vmcnt(15)
    buffer_load_dwordx4 v30, s[28:31], s60 offen offset:2112 nt lds
    s_waitcnt vmcnt(15)
    buffer_load_dwordx4 v31, s[28:31], s60 offen offset:3168 nt lds
    s_add_u32 m0, s54, 4224
    s_waitcnt vmcnt(15)
    buffer_load_dwordx4 v28, s[28:31], s61 offen offset:0 nt lds
    s_waitcnt vmcnt(15)
    buffer_load_dwordx4 v29, s[28:31], s61 offen offset:1056 nt lds
    s_waitcnt vmcnt(15)
    buffer_load_dwordx4 v30, s[28:31], s61 offen offset:2112 nt lds
    s_waitcnt vmcnt(15)
    buffer_load_dwordx4 v31, s[28:31], s61 offen offset:3168 nt lds
    s_add_u32 m0, s54, 8448
    s_waitcnt vmcnt(15)
    buffer_load_dwordx4 v28, s[28:31], s62 offen offset:0 nt lds
    s_waitcnt vmcnt(15)
    buffer_load_dwordx4 v29, s[28:31], s62 offen offset:1056 nt lds
    s_waitcnt vmcnt(15)
    buffer_load_dwordx4 v30, s[28:31], s62 offen offset:2112 nt lds
    s_waitcnt vmcnt(15)
    buffer_load_dwordx4 v31, s[28:31], s62 offen offset:3168 nt lds
    s_add_u32 m0, s54, 12672
    s_waitcnt vmcnt(15)
    buffer_load_dwordx4 v28, s[28:31], s63 offen offset:0 nt lds
    s_waitcnt vmcnt(15)
    buffer_load_dwordx4 v29, s[28:31], s63 offen offset:1056 nt lds
    s_waitcnt vmcnt(15)
    buffer_load_dwordx4 v30, s[28:31], s63 offen offset:2112 nt lds
    s_waitcnt vmcnt(15)
    s_lshl1_add_u32 s52, s50, -1
    v_mov_b32 v37, s52
    ds_write_b32 v36, v37 offset:16
    buffer_load_dwordx4 v31, s[28:31], s63 offen offset:3168 nt lds
    s_branch L_drain
L_pro17:
    s_mov_b32 m0, 8704
    s_nop 0
    buffer_load_dwordx4 v24, s[24:27], s62 offen offset:0 nt lds
    buffer_load_dwordx4 v25, s[24:27], s62 offen offset:1088 nt lds
    buffer_load_dwordx4 v26, s[24:27], s62 offen offset:2176 nt lds
    buffer_load_dwordx4 v27, s[24:27], s62 offen offset:3264 nt lds
    s_mov_b32 m0, 13056
    s_nop 0
    buffer_load_dwordx4 v24, s[24:27], s63 offen offset:0 nt lds
    buffer_load_dwordx4 v25, s[24:27], s63 offen offset:1088 nt lds
    buffer_load_dwordx4 v26, s[24:27], s63 offen offset:2176 nt lds
    buffer_load_dwordx4 v27, s[24:27], s63 offen offset:3264 nt lds
    s_mov_b32 s53, 17408
    s_cmp_ge_u32 s50, s51
    s_cbranch_scc1 L_tail17
L_loop17:
    s_sub_i32 s48, s50, 3
    s_branch L_fchka17
L_fspina17:
    ds_read_b128 v[32:35], v36
L_fchka17:
    s_waitcnt lgkmcnt(0)
    v_min_u32 v32, v32, v33
    v_min3_u32 v32, v32, v34, v35
    s_nop 0
    v_readfirstlane_b32 s47, v32
    s_nop 0
    s_cmp_ge_i32 s47, s48
    s_cbranch_scc0 L_fspina17
    s_add_u32 m0, s53, 0
    s_waitcnt vmcnt(16)
    s_cmp_ge_u32 s50, 2
    s_cbranch_scc0 L_nbka17
    s_lshl1_add_u32 s52, s50, -2
    v_mov_b32 v37, s52
    ds_write_b32 v36, v37 offset:16
L_nbka17:
    buffer_load_dwordx4 v24, s[24:27], s56 offen offset:0 nt lds
    s_waitcnt vmcnt(16)
    buffer_load_dwordx4 v25, s[24:27], s56 offen offset:1088 nt lds
    s_waitcnt vmcnt(16)
    buffer_load_dwordx4 v26, s[24:27], s56 offen offset:2176 nt lds
    s_waitcnt vmcnt(16)
    buffer_load_dwordx4 v27, s[24:27], s56 offen offset:3264 nt lds
    s_add_u32 m0, s53, 4352
    s_waitcnt vmcnt(16)
    buffer_load_dwordx4 v24, s[24:27], s57 offen offset:0 nt lds
    s_waitcnt vmcnt(16)
    buffer_load_dwordx4 v25, s[24:27], s57 offen offset:1088 nt lds
    s_waitcnt vmcnt(16)
    buffer_load_dwordx4 v26, s[24:27], s57 offen offset:2176 nt lds
    s_waitcnt vmcnt(16)
    buffer_load_dwordx4 v27, s[24:27], s57 offen offset:3264 nt lds
    s_add_u32 m0, s53, 8704
    s_waitcnt vmcnt(16)
    buffer_load_dwordx4 v24, s[24:27], s58 offen offset:0 nt lds
    s_waitcnt vmcnt(16)
    buffer_load_dwordx4 v25, s[24:27], s58 offen offset:1088 nt lds
    s_waitcnt vmcnt(16)
    buffer_load_dwordx4 v26, s[24:27], s58 offen offset:2176 nt lds
    s_waitcnt vmcnt(16)
    buffer_load_dwordx4 v27, s[24:27], s58 offen offset:3264 nt lds
    s_add_u32 m0, s53, 13056
    s_waitcnt vmcnt(16)
    buffer_load_dwordx4 v24, s[24:27], s59 offen offset:0 nt lds
    s_waitcnt vmcnt(16)
    buffer_load_dwordx4 v25, s[24:27], s59 offen offset:1088 nt lds
    s_waitcnt vmcnt(16)
    buffer_load_dwordx4 v26, s[24:27], s59 offen offset:2176 nt lds
    s_waitcnt vmcnt(16)
    buffer_load_dwordx4 v27, s[24:27], s59 offen offset:3264 nt lds
    s_add_u32 m0, s54, 0
    s_waitcnt vmcnt(16)
    s_lshl1_add_u32 s52, s50, -1
    v_mov_b32 v37, s52
    ds_write_b32 v36, v37 offset:16
    buffer_load_dwordx4 v28, s[28:31], s60 offen offset:0 nt lds
    s_waitcnt vmcnt(16)
    buffer_load_dwordx4 v29, s[28:31], s60 offen offset:1056 nt lds
    s_waitcnt vmcnt(16)
    buffer_load_dwordx4 v30, s[28:31], s60 offen offset:2112 nt lds
    s_waitcnt vmcnt(16)
    buffer_load_dwordx4 v31, s[28:31], s60 offen offset:3168 nt lds
    s_add_u32 m0, s54, 4224
    s_waitcnt vmcnt(16)
    buffer_load_dwordx4 v28, s[28:31], s61 offen offset:0 nt lds
    s_waitcnt vmcnt(16)
    buffer_load_dwordx4 v29, s[28:31], s61 offen offset:1056 nt lds
    s_waitcnt vmcnt(16)
    buffer_load_dwordx4 v30, s[28:31], s61 offen offset:2112 nt lds
    s_waitcnt vmcnt(16)
    buffer_load_dwordx4 v31, s[28:31], s61 offen offset:3168 nt lds
    s_add_u32 m0, s54, 8448
    s_waitcnt vmcnt(16)
    buffer_load_dwordx4 v28, s[28:31], s62 offen offset:0 nt lds
    s_waitcnt vmcnt(16)
    buffer_load_dwordx4 v29, s[28:31], s62 offen offset:1056 nt lds
    s_waitcnt vmcnt(16)
    buffer_load_dwordx4 v30, s[28:31], s62 offen offset:2112 nt lds
    s_waitcnt vmcnt(16)
    ds_read_b128 v[32:35], v36
    buffer_load_dwordx4 v31, s[28:31], s62 offen offset:3168 nt lds
    s_add_u32 m0, s54, 12672
    s_waitcnt vmcnt(16)
    buffer_load_dwordx4 v28, s[28:31], s63 offen offset:0 nt lds
    s_waitcnt vmcnt(16)
    buffer_load_dwordx4 v29, s[28:31], s63 offen offset:1056 nt lds
    s_waitcnt vmcnt(16)
    buffer_load_dwordx4 v30, s[28:31], s63 offen offset:2112 nt lds
    s_waitcnt vmcnt(16)
    buffer_load_dwordx4 v31, s[28:31], s63 offen offset:3168 nt lds
    s_add_u32 s50, s50, 1
    s_mov_b64 s[60:61], s[56:57]
    s_mov_b64 s[62:63], s[58:59]
    s_cmp_eq_u32 s50, 2
    s_cbranch_scc0 L_tab17
L_tw17:
    ds_read_b128 v[40:43], v36 offset:32
    ds_read_b128 v[20:23], v39
    s_waitcnt lgkmcnt(0)
    v_min3_u32 v40, v40, v41, v42
    v_min_u32 v40, v40, v43
    s_nop 0
    v_readfirstlane_b32 s47, v40
    s_nop 0
    s_cmp_eq_u32 s47, 0
    s_cbranch_scc1 L_tw17
L_tab17:
    v_readlane_b32 s56, v20, s50
    v_readlane_b32 s57, v21, s50
    v_readlane_b32 s58, v22, s50
    v_readlane_b32 s59, v23, s50
    s_add_u32 s53, s53, 17408
    s_cmp_ge_u32 s53, 69632
    s_cselect_b32 s53, 0, s53
    s_add_u32 s54, s54, 16896
    s_cmp_ge_u32 s54, 137216
    s_cselect_b32 s54, 69632, s54
    s_cmp_lt_u32 s50, s51
    s_cbranch_scc1 L_loop17
L_tail17:
    s_sub_i32 s48, s50, 3
    s_branch L_fchkb17
L_fspinb17:
    ds_read_b128 v[32:35], v36
L_fchkb17:
    s_waitcnt lgkmcnt(0)
    v_min_u32 v32, v32, v33
    v_min3_u32 v32, v32, v34, v35
    s_nop 0
    v_readfirstlane_b32 s47, v32
    s_nop 0
    s_cmp_ge_i32 s47, s48
    s_cbranch_scc0 L_fspinb17
    s_add_u32 m0, s54, 0
    s_waitcnt vmcnt(16)
    s_cmp_ge_u32 s50, 2
    s_cbranch_scc0 L_nbkb17
    s_lshl1_add_u32 s52, s50, -2
    v_mov_b32 v37, s52
    ds_write_b32 v36, v37 offset:16
L_nbkb17:
    buffer_load_dwordx4 v28, s[28:31], s60 offen offset:0 nt lds
    s_waitcnt vmcnt(16)
    buffer_load_dwordx4 v29, s[28:31], s60 offen offset:1056 nt lds
    s_waitcnt vmcnt(16)
    buffer_load_dwordx4 v30, s[28:31], s60 offen offset:2112 nt lds
    s_waitcnt vmcnt(16)
    buffer_load_dwordx4 v31, s[28:31], s60 offen offset:3168 nt lds
    s_add_u32 m0, s54, 4224
    s_waitcnt vmcnt(16)
    buffer_load_dwordx4 v28, s[28:31], s61 offen offset:0 nt lds
    s_waitcnt vmcnt(16)
    buffer_load_dwordx4 v29, s[28:31], s61 offen offset:1056 nt lds
    s_waitcnt vmcnt(16)
    buffer_load_dwordx4 v30, s[28:31], s61 offen offset:2112 nt lds
    s_waitcnt vmcnt(16)
    buffer_load_dwordx4 v31, s[28:31], s61 offen offset:3168 nt lds
    s_add_u32 m0, s54, 8448
    s_waitcnt vmcnt(16)
    buffer_load_dwordx4 v28, s[28:31], s62 offen offset:0 nt lds
    s_waitcnt vmcnt(16)
    buffer_load_dwordx4 v29, s[28:31], s62 offen offset:1056 nt lds
    s_waitcnt vmcnt(16)
    buffer_load_dwordx4 v30, s[28:31], s62 offen offset:2112 nt lds
    s_waitcnt vmcnt(16)
    buffer_load_dwordx4 v31, s[28:31], s62 offen offset:3168 nt lds
    s_add_u32 m0, s54, 12672
    s_waitcnt vmcnt(16)
    buffer_load_dwordx4 v28, s[28:31], s63 offen offset:0 nt lds
    s_waitcnt vmcnt(16)
    buffer_load_dwordx4 v29, s[28:31], s63 offen offset:1056 nt lds
    s_waitcnt vmcnt(16)
    buffer_load_dwordx4 v30, s[28:31], s63 offen offset:2112 nt lds
    s_waitcnt vmcnt(16)
    buffer_load_dwordx4 v31, s[28:31], s63 offen offset:3168 nt lds
    s_branch L_drain
L_pro18:
    s_mov_b32 m0, 8704
    s_nop 0
    buffer_load_dwordx4 v24, s[24:27], s62 offen offset:0 nt lds
    buffer_load_dwordx4 v25, s[24:27], s62 offen offset:1088 nt lds
    buffer_load_dwordx4 v26, s[24:27], s62 offen offset:2176 nt lds
    buffer_load_dwordx4 v27, s[24:27], s62 offen offset:3264 nt lds
    s_mov_b32 m0, 13056
    s_nop 0
    buffer_load_dwordx4 v24, s[24:27], s63 offen offset:0 nt lds
    buffer_load_dwordx4 v25, s[24:27], s63 offen offset:1088 nt lds
    buffer_load_dwordx4 v26, s[24:27], s63 offen offset:2176 nt lds
    buffer_load_dwordx4 v27, s[24:27], s63 offen offset:3264 nt lds
    s_mov_b32 s53, 17408
    s_cmp_ge_u32 s50, s51
    s_cbranch_scc1 L_tail18
L_loop18:
    s_sub_i32 s48, s50, 3
    s_branch L_fchka18
L_fspina18:
    ds_read_b128 v[32:35], v36
L_fchka18:
    s_waitcnt lgkmcnt(0)
    v_min_u32 v32, v32, v33
    v_min3_u32 v32, v32, v34, v35
    s_nop 0
    v_readfirstlane_b32 s47, v32
    s_nop 0
    s_cmp_ge_i32 s47, s48
    s_cbranch_scc0 L_fspina18
    s_add_u32 m0, s53, 0
    s_waitcnt vmcnt(17)
    buffer_load_dwordx4 v24, s[24:27], s56 offen offset:0 nt lds
    s_waitcnt vmcnt(17)
    s_cmp_ge_u32 s50, 2
    s_cbranch_scc0 L_nbka18
    s_lshl1_add_u32 s52, s50, -2
    v_mov_b32 v37, s52
    ds_write_b32 v36, v37 offset:16
L_nbka18:
    buffer_load_dwordx4 v25, s[24:27], s56 offen offset:1088 nt lds
    s_waitcnt vmcnt(17)
    buffer_load_dwordx4 v26, s[24:27], s56 offen offset:2176 nt lds
    s_waitcnt vmcnt(17)
    buffer_load_dwordx4 v27, s[24:27], s56 offen offset:3264 nt lds
    s_add_u32 m0, s53, 4352
    s_waitcnt vmcnt(17)
    buffer_load_dwordx4 v24, s[24:27], s57 offen offset:0 nt lds
    s_waitcnt vmcnt(17)
    buffer_load_dwordx4 v25, s[24:27], s57 offen offset:1088 nt lds
    s_waitcnt vmcnt(17)
    buffer_load_dwordx4 v26, s[24:27], s57 offen offset:2176 nt lds
    s_waitcnt vmcnt(17)
    buffer_load_dwordx4 v27, s[24:27], s57 offen offset:3264 nt lds
    s_add_u32 m0, s53, 8704
    s_waitcnt vmcnt(17)
    buffer_load_dwordx4 v24, s[24:27], s58 offen offset:0 nt lds
    s_waitcnt vmcnt(17)
    buffer_load_dwordx4 v25, s[24:27], s58 offen offset:1088 nt lds
    s_waitcnt vmcnt(17)
    buffer_load_dwordx4 v26, s[24:27], s58 offen offset:2176 nt lds
    s_waitcnt vmcnt(17)
    buffer_load_dwordx4 v27, s[24:27], s58 offen offset:3264 nt lds
    s_add_u32 m0, s53, 13056
    s_waitcnt vmcnt(17)
    buffer_load_dwordx4 v24, s[24:27], s59 offen offset:0 nt lds
    s_waitcnt vmcnt(17)
    buffer_load_dwordx4 v25, s[24:27], s59 offen offset:1088 nt lds
    s_waitcnt vmcnt(17)
    buffer_load_dwordx4 v26, s[24:27], s59 offen offset:2176 nt lds
    s_waitcnt vmcnt(17)
    buffer_load_dwordx4 v27, s[24:27], s59 offen offset:3264 nt lds
    s_add_u32 m0, s54, 0
    s_waitcnt vmcnt(17)
    buffer_load_dwordx4 v28, s[28:31], s60 offen offset:0 nt lds
    s_waitcnt vmcnt(17)
    s_lshl1_add_u32 s52, s50, -1
    v_mov_b32 v37, s52
    ds_write_b32 v36, v37 offset:16
    buffer_load_dwordx4 v29, s[28:31], s60 offen offset:1056 nt lds
    s_waitcnt vmcnt(17)
    buffer_load_dwordx4 v30, s[28:31], s60 offen offset:2112 nt lds
    s_waitcnt vmcnt(17)
    buffer_load_dwordx4 v31, s[28:31], s60 offen offset:3168 nt lds
    s_add_u32 m0, s54, 4224
    s_waitcnt vmcnt(17)
    buffer_load_dwordx4 v28, s[28:31], s61 offen offset:0 nt lds
    s_waitcnt vmcnt(17)
    buffer_load_dwordx4 v29, s[28:31], s61 offen offset:1056 nt lds
    s_waitcnt vmcnt(17)
    buffer_load_dwordx4 v30, s[28:31], s61 offen offset:2112 nt lds
    s_waitcnt vmcnt(17)
    buffer_load_dwordx4 v31, s[28:31], s61 offen offset:3168 nt lds
    s_add_u32 m0, s54, 8448
    s_waitcnt vmcnt(17)
    buffer_load_dwordx4 v28, s[28:31], s62 offen offset:0 nt lds
    s_waitcnt vmcnt(17)
    buffer_load_dwordx4 v29, s[28:31], s62 offen offset:1056 nt lds
    s_waitcnt vmcnt(17)
    buffer_load_dwordx4 v30, s[28:31], s62 offen offset:2112 nt lds
    s_waitcnt vmcnt(17)
    ds_read_b128 v[32:35], v36
    buffer_load_dwordx4 v31, s[28:31], s62 offen offset:3168 nt lds
    s_add_u32 m0, s54, 12672
    s_waitcnt vmcnt(17)
    buffer_load_dwordx4 v28, s[28:31], s63 offen offset:0 nt lds
    s_waitcnt vmcnt(17)
    buffer_load_dwordx4 v29, s[28:31], s63 offen offset:1056 nt lds
    s_waitcnt vmcnt(17)
    buffer_load_dwordx4 v30, s[28:31], s63 offen offset:2112 nt lds
    s_waitcnt vmcnt(17)
    buffer_load_dwordx4 v31, s[28:31], s63 offen offset:3168 nt lds
    s_add_u32 s50, s50, 1
    s_mov_b64 s[60:61], s[56:57]
    s_mov_b64 s[62:63], s[58:59]
    s_cmp_eq_u32 s50, 2
    s_cbranch_scc0 L_tab18
L_tw18:
    ds_read_b128 v[40:43], v36 offset:32
    ds_read_b128 v[20:23], v39
    s_waitcnt lgkmcnt(0)
    v_min3_u32 v40, v40, v41, v42
    v_min_u32 v40, v40, v43
    s_nop 0
    v_readfirstlane_b32 s47, v40
    s_nop 0
    s_cmp_eq_u32 s47, 0
    s_cbranch_scc1 L_tw18
L_tab18:
    v_readlane_b32 s56, v20, s50
    v_readlane_b32 s57, v21, s50
    v_readlane_b32 s58, v22, s50
    v_readlane_b32 s59, v23, s50
    s_add_u32 s53, s53, 17408
    s_cmp_ge_u32 s53, 69632
    s_cselect_b32 s53, 0, s53
    s_add_u32 s54, s54, 16896
    s_cmp_ge_u32 s54, 137216
    s_cselect_b32 s54, 69632, s54
    s_cmp_lt_u32 s50, s51
    s_cbranch_scc1 L_loop18
L_tail18:
    s_sub_i32 s48, s50, 3
    s_branch L_fchkb18
L_fspinb18:
    ds_read_b128 v[32:35], v36
L_fchkb18:
    s_waitcnt lgkmcnt(0)
    v_min_u32 v32, v32, v33
    v_min3_u32 v32, v32, v34, v35
    s_nop 0
    v_readfirstlane_b32 s47, v32
    s_nop 0
    s_cmp_ge_i32 s47, s48
    s_cbranch_scc0 L_fspinb18
    s_add_u32 m0, s54, 0
    s_waitcnt vmcnt(17)
    buffer_load_dwordx4 v28, s[28:31], s60 offen offset:0 nt lds
    s_waitcnt vmcnt(17)
    s_cmp_ge_u32 s50, 2
    s_cbranch_scc0 L_nbkb18
    s_lshl1_add_u32 s52, s50, -2
    v_mov_b32 v37, s52
    ds_write_b32 v36, v37 offset:16
L_nbkb18:
    buffer_load_dwordx4 v29, s[28:31], s60 offen offset:1056 nt lds
    s_waitcnt vmcnt(17)
    buffer_load_dwordx4 v30, s[28:31], s60 offen offset:2112 nt lds
    s_waitcnt vmcnt(17)
    buffer_load_dwordx4 v31, s[28:31], s60 offen offset:3168 nt lds
    s_add_u32 m0, s54, 4224
    s_waitcnt vmcnt(17)
    buffer_load_dwordx4 v28, s[28:31], s61 offen offset:0 nt lds
    s_waitcnt vmcnt(17)
    buffer_load_dwordx4 v29, s[28:31], s61 offen offset:1056 nt lds
    s_waitcnt vmcnt(17)
    buffer_load_dwordx4 v30, s[28:31], s61 offen offset:2112 nt lds
    s_waitcnt vmcnt(17)
    buffer_load_dwordx4 v31, s[28:31], s61 offen offset:3168 nt lds
    s_add_u32 m0, s54, 8448
    s_waitcnt vmcnt(17)
    buffer_load_dwordx4 v28, s[28:31], s62 offen offset:0 nt lds
    s_waitcnt vmcnt(17)
    buffer_load_dwordx4 v29, s[28:31], s62 offen offset:1056 nt lds
    s_waitcnt vmcnt(17)
    buffer_load_dwordx4 v30, s[28:31], s62 offen offset:2112 nt lds
    s_waitcnt vmcnt(17)
    buffer_load_dwordx4 v31, s[28:31], s62 offen offset:3168 nt lds
    s_add_u32 m0, s54, 12672
    s_waitcnt vmcnt(17)
    buffer_load_dwordx4 v28, s[28:31], s63 offen offset:0 nt lds
    s_waitcnt vmcnt(17)
    buffer_load_dwordx4 v29, s[28:31], s63 offen offset:1056 nt lds
    s_waitcnt vmcnt(17)
    buffer_load_dwordx4 v30, s[28:31], s63 offen offset:2112 nt lds
    s_waitcnt vmcnt(17)
    buffer_load_dwordx4 v31, s[28:31], s63 offen offset:3168 nt lds
    s_branch L_drain
L_pro19:
    s_mov_b32 m0, 8704
    s_nop 0
    buffer_load_dwordx4 v24, s[24:27], s62 offen offset:0 nt lds
    buffer_load_dwordx4 v25, s[24:27], s62 offen offset:1088 nt lds
    buffer_load_dwordx4 v26, s[24:27], s62 offen offset:2176 nt lds
    buffer_load_dwordx4 v27, s[24:27], s62 offen offset:3264 nt lds
    s_mov_b32 m0, 13056
    s_nop 0
    buffer_load_dwordx4 v24, s[24:27], s63 offen offset:0 nt lds
    buffer_load_dwordx4 v25, s[24:27], s63 offen offset:1088 nt lds
    buffer_load_dwordx4 v26, s[24:27], s63 offen offset:2176 nt lds
    buffer_load_dwordx4 v27, s[24:27], s63 offen offset:3264 nt lds
    s_mov_b32 s53, 17408
    s_cmp_ge_u32 s50, s51
    s_cbranch_scc1 L_tail19
L_loop19:
    s_sub_i32 s48, s50, 3
    s_branch L_fchka19
L_fspina19:
    ds_read_b128 v[32:35], v36
L_fchka19:
    s_waitcnt lgkmcnt(0)
    v_min_u32 v32, v32, v33
    v_min3_u32 v32, v32, v34, v35
    s_nop 0
    v_readfirstlane_b32 s47, v32
    s_nop 0
    s_cmp_ge_i32 s47, s48
    s_cbranch_scc0 L_fspina19
    s_add_u32 m0, s53, 0
    s_waitcnt vmcnt(18)
    buffer_load_dwordx4 v24, s[24:27], s56 offen offset:0 nt lds
    s_waitcnt vmcnt(18)
    buffer_load_dwordx4 v25, s[24:27], s56 offen offset:1088 nt lds
    s_waitcnt vmcnt(18)
    s_cmp_ge_u32 s50, 2
    s_cbranch_scc0 L_nbka19
    s_lshl1_add_u32 s52, s50, -2
    v_mov_b32 v37, s52
    ds_write_b32 v36, v37 offset:16
L_nbka19:
    buffer_load_dwordx4 v26, s[24:27], s56 offen offset:2176 nt lds
    s_waitcnt vmcnt(18)
    buffer_load_dwordx4 v27, s[24:27], s56 offen offset:3264 nt lds
    s_add_u32 m0, s53, 4352
    s_waitcnt vmcnt(18)
    buffer_load_dwordx4 v24, s[24:27], s57 offen offset:0 nt lds
    s_waitcnt vmcnt(18)
    buffer_load_dwordx4 v25, s[24:27], s57 offen offset:1088 nt lds
    s_waitcnt vmcnt(18)
    buffer_load_dwordx4 v26, s[24:27], s57 offen offset:2176 nt lds
    s_waitcnt vmcnt(18)
    buffer_load_dwordx4 v27, s[24:27], s57 offen offset:3264 nt lds
    s_add_u32 m0, s53, 8704
    s_waitcnt vmcnt(18)
    buffer_load_dwordx4 v24, s[24:27], s58 offen offset:0 nt lds
    s_waitcnt vmcnt(18)
    buffer_load_dwordx4 v25, s[24:27], s58 offen offset:1088 nt lds
    s_waitcnt vmcnt(18)
    buffer_load_dwordx4 v26, s[24:27], s58 offen offset:2176 nt lds
    s_waitcnt vmcnt(18)
    buffer_load_dwordx4 v27, s[24:27], s58 offen offset:3264 nt lds
    s_add_u32 m0, s53, 13056
    s_waitcnt vmcnt(18)
    buffer_load_dwordx4 v24, s[24:27], s59 offen offset:0 nt lds
    s_waitcnt vmcnt(18)
    buffer_load_dwordx4 v25, s[24:27], s59 offen offset:1088 nt lds
    s_waitcnt vmcnt(18)
    buffer_load_dwordx4 v26, s[24:27], s59 offen offset:2176 nt lds
    s_waitcnt vmcnt(18)
    buffer_load_dwordx4 v27, s[24:27], s59 offen offset:3264 nt lds
    s_add_u32 m0, s54, 0
    s_waitcnt vmcnt(18)
    buffer_load_dwordx4 v28, s[28:31], s60 offen offset:0 nt lds
    s_waitcnt vmcnt(18)
    buffer_load_dwordx4 v29, s[28:31], s60 offen offset:1056 nt lds
    s_waitcnt vmcnt(18)
    s_lshl1_add_u32 s52, s50, -1
    v_mov_b32 v37, s52
    ds_write_b32 v36, v37 offset:16
    buffer_load_dwordx4 v30, s[28:31], s60 offen offset:2112 nt lds
    s_waitcnt vmcnt(18)
    buffer_load_dwordx4 v31, s[28:31], s60 offen offset:3168 nt lds
    s_add_u32 m0, s54, 4224
    s_waitcnt vmcnt(18)
    buffer_load_dwordx4 v28, s[28:31], s61 offen offset:0 nt lds
    s_waitcnt vmcnt(18)
    buffer_load_dwordx4 v29, s[28:31], s61 offen offset:1056 nt lds
    s_waitcnt vmcnt(18)
    buffer_load_dwordx4 v30, s[28:31], s61 offen offset:2112 nt lds
    s_waitcnt vmcnt(18)
    buffer_load_dwordx4 v31, s[28:31], s61 offen offset:3168 nt lds
    s_add_u32 m0, s54, 8448
    s_waitcnt vmcnt(18)
    buffer_load_dwordx4 v28, s[28:31], s62 offen offset:0 nt lds
    s_waitcnt vmcnt(18)
    buffer_load_dwordx4 v29, s[28:31], s62 offen offset:1056 nt lds
    s_waitcnt vmcnt(18)
    buffer_load_dwordx4 v30, s[28:31], s62 offen offset:2112 nt lds
    s_waitcnt vmcnt(18)
    ds_read_b128 v[32:35], v36
    buffer_load_dwordx4 v31, s[28:31], s62 offen offset:3168 nt lds
    s_add_u32 m0, s54, 12672
    s_waitcnt vmcnt(18)
    buffer_load_dwordx4 v28, s[28:31], s63 offen offset:0 nt lds
    s_waitcnt vmcnt(18)
    buffer_load_dwordx4 v29, s[28:31], s63 offen offset:1056 nt lds
    s_waitcnt vmcnt(18)
    buffer_load_dwordx4 v30, s[28:31], s63 offen offset:2112 nt lds
    s_waitcnt vmcnt(18)
    buffer_load_dwordx4 v31, s[28:31], s63 offen offset:3168 nt lds
    s_add_u32 s50, s50, 1
    s_mov_b64 s[60:61], s[56:57]
    s_mov_b64 s[62:63], s[58:59]
    s_cmp_eq_u32 s50, 2
    s_cbranch_scc0 L_tab19
L_tw19:
    ds_read_b128 v[40:43], v36 offset:32
    ds_read_b128 v[20:23], v39
    s_waitcnt lgkmcnt(0)
    v_min3_u32 v40, v40, v41, v42
    v_min_u32 v40, v40, v43
    s_nop 0
    v_readfirstlane_b32 s47, v40
    s_nop 0
    s_cmp_eq_u32 s47, 0
    s_cbranch_scc1 L_tw19
L_tab19:
    v_readlane_b32 s56, v20, s50
    v_readlane_b32 s57, v21, s50
    v_readlane_b32 s58, v22, s50
    v_readlane_b32 s59, v23, s50
    s_add_u32 s53, s53, 17408
    s_cmp_ge_u32 s53, 69632
    s_cselect_b32 s53, 0, s53
    s_add_u32 s54, s54, 16896
    s_cmp_ge_u32 s54, 137216
    s_cselect_b32 s54, 69632, s54
    s_cmp_lt_u32 s50, s51
    s_cbranch_scc1 L_loop19
L_tail19:
    s_sub_i32 s48, s50, 3
    s_branch L_fchkb19
L_fspinb19:
    ds_read_b128 v[32:35], v36
L_fchkb19:
    s_waitcnt lgkmcnt(0)
    v_min_u32 v32, v32, v33
    v_min3_u32 v32, v32, v34, v35
    s_nop 0
    v_readfirstlane_b32 s47, v32
    s_nop 0
    s_cmp_ge_i32 s47, s48
    s_cbranch_scc0 L_fspinb19
    s_add_u32 m0, s54, 0
    s_waitcnt vmcnt(18)
    buffer_load_dwordx4 v28, s[28:31], s60 offen offset:0 nt lds
    s_waitcnt vmcnt(18)
    buffer_load_dwordx4 v29, s[28:31], s60 offen offset:1056 nt lds
    s_waitcnt vmcnt(18)
    s_cmp_ge_u32 s50, 2
    s_cbranch_scc0 L_nbkb19
    s_lshl1_add_u32 s52, s50, -2
    v_mov_b32 v37, s52
    ds_write_b32 v36, v37 offset:16
L_nbkb19:
    buffer_load_dwordx4 v30, s[28:31], s60 offen offset:2112 nt lds
    s_waitcnt vmcnt(18)
    buffer_load_dwordx4 v31, s[28:31], s60 offen offset:3168 nt lds
    s_add_u32 m0, s54, 4224
    s_waitcnt vmcnt(18)
    buffer_load_dwordx4 v28, s[28:31], s61 offen offset:0 nt lds
    s_waitcnt vmcnt(18)
    buffer_load_dwordx4 v29, s[28:31], s61 offen offset:1056 nt lds
    s_waitcnt vmcnt(18)
    buffer_load_dwordx4 v30, s[28:31], s61 offen offset:2112 nt lds
    s_waitcnt vmcnt(18)
    buffer_load_dwordx4 v31, s[28:31], s61 offen offset:3168 nt lds
    s_add_u32 m0, s54, 8448
    s_waitcnt vmcnt(18)
    buffer_load_dwordx4 v28, s[28:31], s62 offen offset:0 nt lds
    s_waitcnt vmcnt(18)
    buffer_load_dwordx4 v29, s[28:31], s62 offen offset:1056 nt lds
    s_waitcnt vmcnt(18)
    buffer_load_dwordx4 v30, s[28:31], s62 offen offset:2112 nt lds
    s_waitcnt vmcnt(18)
    buffer_load_dwordx4 v31, s[28:31], s62 offen offset:3168 nt lds
    s_add_u32 m0, s54, 12672
    s_waitcnt vmcnt(18)
    buffer_load_dwordx4 v28, s[28:31], s63 offen offset:0 nt lds
    s_waitcnt vmcnt(18)
    buffer_load_dwordx4 v29, s[28:31], s63 offen offset:1056 nt lds
    s_waitcnt vmcnt(18)
    buffer_load_dwordx4 v30, s[28:31], s63 offen offset:2112 nt lds
    s_waitcnt vmcnt(18)
    buffer_load_dwordx4 v31, s[28:31], s63 offen offset:3168 nt lds
    s_branch L_drain
L_pro20:
    s_mov_b32 m0, 8704
    s_nop 0
    buffer_load_dwordx4 v24, s[24:27], s62 offen offset:0 nt lds
    buffer_load_dwordx4 v25, s[24:27], s62 offen offset:1088 nt lds
    buffer_load_dwordx4 v26, s[24:27], s62 offen offset:2176 nt lds
    buffer_load_dwordx4 v27, s[24:27], s62 offen offset:3264 nt lds
    s_mov_b32 m0, 13056
    s_nop 0
    buffer_load_dwordx4 v24, s[24:27], s63 offen offset:0 nt lds
    buffer_load_dwordx4 v25, s[24:27], s63 offen offset:1088 nt lds
    buffer_load_dwordx4 v26, s[24:27], s63 offen offset:2176 nt lds
    buffer_load_dwordx4 v27, s[24:27], s63 offen offset:3264 nt lds
    s_mov_b32 s53, 17408
    s_cmp_ge_u32 s50, s51
    s_cbranch_scc1 L_tail20
    s_mov_b32 m0, 17408
    s_nop 0
    buffer_load_dwordx4 v24, s[24:27], s56 offen offset:0 nt lds
    buffer_load_dwordx4 v25, s[24:27], s56 offen offset:1088 nt lds
    buffer_load_dwordx4 v26, s[24:27], s56 offen offset:2176 nt lds
    buffer_load_dwordx4 v27, s[24:27], s56 offen offset:3264 nt lds
    s_branch L_mid20
L_loop20:
    s_sub_i32 s48, s50, 3
    s_branch L_fchka20
L_fspina20:
    ds_read_b128 v[32:35], v36
L_fchka20:
    s_waitcnt lgkmcnt(0)
    v_min_u32 v32, v32, v33
    v_min3_u32 v32, v32, v34, v35
    s_nop 0
    v_readfirstlane_b32 s47, v32
    s_nop 0
    s_cmp_ge_i32 s47, s48
    s_cbranch_scc0 L_fspina20
    s_add_u32 m0, s53, 0
    s_waitcnt vmcnt(19)
    buffer_load_dwordx4 v24, s[24:27], s56 offen offset:0 nt lds
    s_waitcnt vmcnt(19)
    buffer_load_dwordx4 v25, s[24:27], s56 offen offset:1088 nt lds
    s_waitcnt vmcnt(19)
    buffer_load_dwordx4 v26, s[24:27], s56 offen offset:2176 nt lds
    s_waitcnt vmcnt(19)
    s_cmp_ge_u32 s50, 2
    s_cbranch_scc0 L_nbka20
    s_lshl1_add_u32 s52, s50, -2
    v_mov_b32 v37, s52
    ds_write_b32 v36, v37 offset:16
L_nbka20:
    buffer_load_dwordx4 v27, s[24:27], s56 offen offset:3264 nt lds
L_mid20:
    s_add_u32 m0, s53, 4352
    s_waitcnt vmcnt(19)
    buffer_load_dwordx4 v24, s[24:27], s57 offen offset:0 nt lds
    s_waitcnt vmcnt(19)
    buffer_load_dwordx4 v25, s[24:27], s57 offen offset:1088 nt lds
    s_waitcnt vmcnt(19)
    buffer_load_dwordx4 v26, s[24:27], s57 offen offset:2176 nt lds
    s_waitcnt vmcnt(19)
    buffer_load_dwordx4 v27, s[24:27], s57 offen offset:3264 nt lds
    s_add_u32 m0, s53, 8704
    s_waitcnt vmcnt(19)
    buffer_load_dwordx4 v24, s[24:27], s58 offen offset:0 nt lds
    s_waitcnt vmcnt(19)
    buffer_load_dwordx4 v25, s[24:27], s58 offen offset:1088 nt lds
    s_waitcnt vmcnt(19)
    buffer_load_dwordx4 v26, s[24:27], s58 offen offset:2176 nt lds
    s_waitcnt vmcnt(19)
    buffer_load_dwordx4 v27, s[24:27], s58 offen offset:3264 nt lds
    s_add_u32 m0, s53, 13056
    s_waitcnt vmcnt(19)
    buffer_load_dwordx4 v24, s[24:27], s59 offen offset:0 nt lds
    s_waitcnt vmcnt(19)
    buffer_load_dwordx4 v25, s[24:27], s59 offen offset:1088 nt lds
    s_waitcnt vmcnt(19)
    buffer_load_dwordx4 v26, s[24:27], s59 offen offset:2176 nt lds
    s_waitcnt vmcnt(19)
    buffer_load_dwordx4 v27, s[24:27], s59 offen offset:3264 nt lds
    s_add_u32 m0, s54, 0
    s_waitcnt vmcnt(19)
    buffer_load_dwordx4 v28, s[28:31], s60 offen offset:0 nt lds
    s_waitcnt vmcnt(19)
    buffer_load_dwordx4 v29, s[28:31], s60 offen offset:1056 nt lds
    s_waitcnt vmcnt(19)
    buffer_load_dwordx4 v30, s[28:31], s60 offen offset:2112 nt lds
    s_waitcnt vmcnt(19)
    s_lshl1_add_u32 s52, s50, -1
    v_mov_b32 v37, s52
    ds_write_b32 v36, v37 offset:16
    buffer_load_dwordx4 v31, s[28:31], s60 offen offset:3168 nt lds
    s_add_u32 m0, s54, 4224
    s_waitcnt vmcnt(19)
    buffer_load_dwordx4 v28, s[28:31], s61 offen offset:0 nt lds
    s_waitcnt vmcnt(19)
    buffer_load_dwordx4 v29, s[28:31], s61 offen offset:1056 nt lds
    s_waitcnt vmcnt(19)
    buffer_load_dwordx4 v30, s[28:31], s61 offen offset:2112 nt lds
    s_waitcnt vmcnt(19)
    buffer_load_dwordx4 v31, s[28:31], s61 offen offset:3168 nt lds
    s_add_u32 m0, s54, 8448
    s_waitcnt vmcnt(19)
    buffer_load_dwordx4 v28, s[28:31], s62 offen offset:0 nt lds
    s_waitcnt vmcnt(19)
    buffer_load_dwordx4 v29, s[28:31], s62 offen offset:1056 nt lds
    s_waitcnt vmcnt(19)
    buffer_load_dwordx4 v30, s[28:31], s62 offen offset:2112 nt lds
    s_waitcnt vmcnt(19)
    ds_read_b128 v[32:35], v36
    buffer_load_dwordx4 v31, s[28:31], s62 offen offset:3168 nt lds
    s_add_u32 m0, s54, 12672
    s_waitcnt vmcnt(19)
    buffer_load_dwordx4 v28, s[28:31], s63 offen offset:0 nt lds
    s_waitcnt vmcnt(19)
    buffer_load_dwordx4 v29, s[28:31], s63 offen offset:1056 nt lds
    s_waitcnt vmcnt(19)
    buffer_load_dwordx4 v30, s[28:31], s63 offen offset:2112 nt lds
    s_waitcnt vmcnt(19)
    buffer_load_dwordx4 v31, s[28:31], s63 offen offset:3168 nt lds
    s_add_u32 s50, s50, 1
    s_mov_b64 s[60:61], s[56:57]
    s_mov_b64 s[62:63], s[58:59]
    s_cmp_eq_u32 s50, 2
    s_cbranch_scc0 L_tab20
L_tw20:
    ds_read_b128 v[40:43], v36 offset:32
    ds_read_b128 v[20:23], v39
    s_waitcnt lgkmcnt(0)
    v_min3_u32 v40, v40, v41, v42
    v_min_u32 v40, v40, v43
    s_nop 0
    v_readfirstlane_b32 s47, v40
    s_nop 0
    s_cmp_eq_u32 s47, 0
    s_cbranch_scc1 L_tw20
L_tab20:
    v_readlane_b32 s56, v20, s50
    v_readlane_b32 s57, v21, s50
    v_readlane_b32 s58, v22, s50
    v_readlane_b32 s59, v23, s50
    s_add_u32 s53, s53, 17408
    s_cmp_ge_u32 s53, 69632
    s_cselect_b32 s53, 0, s53
    s_add_u32 s54, s54, 16896
    s_cmp_ge_u32 s54, 137216
    s_cselect_b32 s54, 69632, s54
    s_cmp_lt_u32 s50, s51
    s_cbranch_scc1 L_loop20
L_tail20:
    s_sub_i32 s48, s50, 3
    s_branch L_fchkb20
L_fspinb20:
    ds_read_b128 v[32:35], v36
L_fchkb20:
    s_waitcnt lgkmcnt(0)
    v_min_u32 v32, v32, v33
    v_min3_u32 v32, v32, v34, v35
    s_nop 0
    v_readfirstlane_b32 s47, v32
    s_nop 0
    s_cmp_ge_i32 s47, s48
    s_cbranch_scc0 L_fspinb20
    s_add_u32 m0, s54, 0
    s_waitcnt vmcnt(19)
    buffer_load_dwordx4 v28, s[28:31], s60 offen offset:0 nt lds
    s_waitcnt vmcnt(19)
    buffer_load_dwordx4 v29, s[28:31], s60 offen offset:1056 nt lds
    s_waitcnt vmcnt(19)
    buffer_load_dwordx4 v30, s[28:31], s60 offen offset:2112 nt lds
    s_waitcnt vmcnt(19)
    s_cmp_ge_u32 s50, 2
    s_cbranch_scc0 L_nbkb20
    s_lshl1_add_u32 s52, s50, -2
    v_mov_b32 v37, s52
    ds_write_b32 v36, v37 offset:16
L_nbkb20:
    buffer_load_dwordx4 v31, s[28:31], s60 offen offset:3168 nt lds
    s_add_u32 m0, s54, 4224
    s_waitcnt vmcnt(19)
    buffer_load_dwordx4 v28, s[28:31], s61 offen offset:0 nt lds
    s_waitcnt vmcnt(19)
    buffer_load_dwordx4 v29, s[28:31], s61 offen offset:1056 nt lds
    s_waitcnt vmcnt(19)
    buffer_load_dwordx4 v30, s[28:31], s61 offen offset:2112 nt lds
    s_waitcnt vmcnt(19)
    buffer_load_dwordx4 v31, s[28:31], s61 offen offset:3168 nt lds
    s_add_u32 m0, s54, 8448
    s_waitcnt vmcnt(19)
    buffer_load_dwordx4 v28, s[28:31], s62 offen offset:0 nt lds
    s_waitcnt vmcnt(19)
    buffer_load_dwordx4 v29, s[28:31], s62 offen offset:1056 nt lds
    s_waitcnt vmcnt(19)
    buffer_load_dwordx4 v30, s[28:31], s62 offen offset:2112 nt lds
    s_waitcnt vmcnt(19)
    buffer_load_dwordx4 v31, s[28:31], s62 offen offset:3168 nt lds
    s_add_u32 m0, s54, 12672
    s_waitcnt vmcnt(19)
    buffer_load_dwordx4 v28, s[28:31], s63 offen offset:0 nt lds
    s_waitcnt vmcnt(19)
    buffer_load_dwordx4 v29, s[28:31], s63 offen offset:1056 nt lds
    s_waitcnt vmcnt(19)
    buffer_load_dwordx4 v30, s[28:31], s63 offen offset:2112 nt lds
    s_waitcnt vmcnt(19)
    buffer_load_dwordx4 v31, s[28:31], s63 offen offset:3168 nt lds
    s_branch L_drain
L_pro21:
    s_mov_b32 m0, 8704
    s_nop 0
    buffer_load_dwordx4 v24, s[24:27], s62 offen offset:0 nt lds
    buffer_load_dwordx4 v25, s[24:27], s62 offen offset:1088 nt lds
    buffer_load_dwordx4 v26, s[24:27], s62 offen offset:2176 nt lds
    buffer_load_dwordx4 v27, s[24:27], s62 offen offset:3264 nt lds
    s_mov_b32 m0, 13056
    s_nop 0
    buffer_load_dwordx4 v24, s[24:27], s63 offen offset:0 nt lds
    buffer_load_dwordx4 v25, s[24:27], s63 offen offset:1088 nt lds
    buffer_load_dwordx4 v26, s[24:27], s63 offen offset:2176 nt lds
    buffer_load_dwordx4 v27, s[24:27], s63 offen offset:3264 nt lds
    s_mov_b32 s53, 17408
    s_cmp_ge_u32 s50, s51
    s_cbranch_scc1 L_tail21
    s_mov_b32 m0, 17408
    s_nop 0
    buffer_load_dwordx4 v24, s[24:27], s56 offen offset:0 nt lds
    buffer_load_dwordx4 v25, s[24:27], s56 offen offset:1088 nt lds
    buffer_load_dwordx4 v26, s[24:27], s56 offen offset:2176 nt lds
    buffer_load_dwordx4 v27, s[24:27], s56 offen offset:3264 nt lds
    s_branch L_mid21
L_loop21:
    s_sub_i32 s48, s50, 3
    s_branch L_fchka21
L_fspina21:
    ds_read_b128 v[32:35], v36
L_fchka21:
    s_waitcnt lgkmcnt(0)
    v_min_u32 v32, v32, v33
    v_min3_u32 v32, v32, v34, v35
    s_nop 0
    v_readfirstlane_b32 s47, v32
    s_nop 0
    s_cmp_ge_i32 s47, s48
    s_cbranch_scc0 L_fspina21
    s_add_u32 m0, s53, 0
    s_waitcnt vmcnt(20)
    buffer_load_dwordx4 v24, s[24:27], s56 offen offset:0 nt lds
    s_waitcnt vmcnt(20)
    buffer_load_dwordx4 v25, s[24:27], s56 offen offset:1088 nt lds
    s_waitcnt vmcnt(20)
    buffer_load_dwordx4 v26, s[24:27], s56 offen offset:2176 nt lds
    s_waitcnt vmcnt(20)
    buffer_load_dwordx4 v27, s[24:27], s56 offen offset:3264 nt lds
L_mid21:
    s_add_u32 m0, s53, 4352
    s_waitcnt vmcnt(20)
    s_cmp_ge_u32 s50, 2
    s_cbranch_scc0 L_nbka21
    s_lshl1_add_u32 s52, s50, -2
    v_mov_b32 v37, s52
    ds_write_b32 v36, v37 offset:16
L_nbka21:
    buffer_load_dwordx4 v24, s[24:27], s57 offen offset:0 nt lds
    s_waitcnt vmcnt(20)
    buffer_load_dwordx4 v25, s[24:27], s57 offen offset:1088 nt lds
    s_waitcnt vmcnt(20)
    buffer_load_dwordx4 v26, s[24:27], s57 offen offset:2176 nt lds
    s_waitcnt vmcnt(20)
    buffer_load_dwordx4 v27, s[24:27], s57 offen offset:3264 nt lds
    s_add_u32 m0, s53, 8704
    s_waitcnt vmcnt(20)
    buffer_load_dwordx4 v24, s[24:27], s58 offen offset:0 nt lds
    s_waitcnt vmcnt(20)
    buffer_load_dwordx4 v25, s[24:27], s58 offen offset:1088 nt lds
    s_waitcnt vmcnt(20)
    buffer_load_dwordx4 v26, s[24:27], s58 offen offset:2176 nt lds
    s_waitcnt vmcnt(20)
    buffer_load_dwordx4 v27, s[24:27], s58 offen offset:3264 nt lds
    s_add_u32 m0, s53, 13056
    s_waitcnt vmcnt(20)
    buffer_load_dwordx4 v24, s[24:27], s59 offen offset:0 nt lds
    s_waitcnt vmcnt(20)
    buffer_load_dwordx4 v25, s[24:27], s59 offen offset:1088 nt lds
    s_waitcnt vmcnt(20)
    buffer_load_dwordx4 v26, s[24:27], s59 offen offset:2176 nt lds
    s_waitcnt vmcnt(20)
    buffer_load_dwordx4 v27, s[24:27], s59 offen offset:3264 nt lds
    s_add_u32 m0, s54, 0
    s_waitcnt vmcnt(20)
    buffer_load_dwordx4 v28, s[28:31], s60 offen offset:0 nt lds
    s_waitcnt vmcnt(20)
    buffer_load_dwordx4 v29, s[28:31], s60 offen offset:1056 nt lds
    s_waitcnt vmcnt(20)
    buffer_load_dwordx4 v30, s[28:31], s60 offen offset:2112 nt lds
    s_waitcnt vmcnt(20)
    buffer_load_dwordx4 v31, s[28:31], s60 offen offset:3168 nt lds
    s_add_u32 m0, s54, 4224
    s_waitcnt vmcnt(20)
    s_lshl1_add_u32 s52, s50, -1
    v_mov_b32 v37, s52
    ds_write_b32 v36, v37 offset:16
    buffer_load_dwordx4 v28, s[28:31], s61 offen offset:0 nt lds
    s_waitcnt vmcnt(20)
    buffer_load_dwordx4 v29, s[28:31], s61 offen offset:1056 nt lds
    s_waitcnt vmcnt(20)
    buffer_load_dwordx4 v30, s[28:31], s61 offen offset:2112 nt lds
    s_waitcnt vmcnt(20)
    buffer_load_dwordx4 v31, s[28:31], s61 offen offset:3168 nt lds
    s_add_u32 m0, s54, 8448
    s_waitcnt vmcnt(20)
    buffer_load_dwordx4 v28, s[28:31], s62 offen offset:0 nt lds
    s_waitcnt vmcnt(20)
    buffer_load_dwordx4 v29, s[28:31], s62 offen offset:1056 nt lds
    s_waitcnt vmcnt(20)
    buffer_load_dwordx4 v30, s[28:31], s62 offen offset:2112 nt lds
    s_waitcnt vmcnt(20)
    ds_read_b128 v[32:35], v36
    buffer_load_dwordx4 v31, s[28:31], s62 offen offset:3168 nt lds
    s_add_u32 m0, s54, 12672
    s_waitcnt vmcnt(20)
    buffer_load_dwordx4 v28, s[28:31], s63 offen offset:0 nt lds
    s_waitcnt vmcnt(20)
    buffer_load_dwordx4 v29, s[28:31], s63 offen offset:1056 nt lds
    s_waitcnt vmcnt(20)
    buffer_load_dwordx4 v30, s[28:31], s63 offen offset:2112 nt lds
    s_waitcnt vmcnt(20)
    buffer_load_dwordx4 v31, s[28:31], s63 offen offset:3168 nt lds
    s_add_u32 s50, s50, 1
    s_mov_b64 s[60:61], s[56:57]
    s_mov_b64 s[62:63], s[58:59]
    s_cmp_eq_u32 s50, 2
    s_cbranch_scc0 L_tab21
L_tw21:
    ds_read_b128 v[40:43], v36 offset:32
    ds_read_b128 v[20:23], v39
    s_waitcnt lgkmcnt(0)
    v_min3_u32 v40, v40, v41, v42
    v_min_u32 v40, v40, v43
    s_nop 0
    v_readfirstlane_b32 s47, v40
    s_nop 0
    s_cmp_eq_u32 s47, 0
    s_cbranch_scc1 L_tw21
L_tab21:
    v_readlane_b32 s56, v20, s50
    v_readlane_b32 s57, v21, s50
    v_readlane_b32 s58, v22, s50
    v_readlane_b32 s59, v23, s50
    s_add_u32 s53, s53, 17408
    s_cmp_ge_u32 s53, 69632
    s_cselect_b32 s53, 0, s53
    s_add_u32 s54, s54, 16896
    s_cmp_ge_u32 s54, 137216
    s_cselect_b32 s54, 69632, s54
    s_cmp_lt_u32 s50, s51
    s_cbranch_scc1 L_loop21
L_tail21:
    s_sub_i32 s48, s50, 3
    s_branch L_fchkb21
L_fspinb21:
    ds_read_b128 v[32:35], v36
L_fchkb21:
    s_waitcnt lgkmcnt(0)
    v_min_u32 v32, v32, v33
    v_min3_u32 v32, v32, v34, v35
    s_nop 0
    v_readfirstlane_b32 s47, v32
    s_nop 0
    s_cmp_ge_i32 s47, s48
    s_cbranch_scc0 L_fspinb21
    s_add_u32 m0, s54, 0
    s_waitcnt vmcnt(20)
    buffer_load_dwordx4 v28, s[28:31], s60 offen offset:0 nt lds
    s_waitcnt vmcnt(20)
    buffer_load_dwordx4 v29, s[28:31], s60 offen offset:1056 nt lds
    s_waitcnt vmcnt(20)
    buffer_load_dwordx4 v30, s[28:31], s60 offen offset:2112 nt lds
    s_waitcnt vmcnt(20)
    buffer_load_dwordx4 v31, s[28:31], s60 offen offset:3168 nt lds
    s_add_u32 m0, s54, 4224
    s_waitcnt vmcnt(20)
    s_cmp_ge_u32 s50, 2
    s_cbranch_scc0 L_nbkb21
    s_lshl1_add_u32 s52, s50, -2
    v_mov_b32 v37, s52
    ds_write_b32 v36, v37 offset:16
L_nbkb21:
    buffer_load_dwordx4 v28, s[28:31], s61 offen offset:0 nt lds
    s_waitcnt vmcnt(20)
    buffer_load_dwordx4 v29, s[28:31], s61 offen offset:1056 nt lds
    s_waitcnt vmcnt(20)
    buffer_load_dwordx4 v30, s[28:31], s61 offen offset:2112 nt lds
    s_waitcnt vmcnt(20)
    buffer_load_dwordx4 v31, s[28:31], s61 offen offset:3168 nt lds
    s_add_u32 m0, s54, 8448
    s_waitcnt vmcnt(20)
    buffer_load_dwordx4 v28, s[28:31], s62 offen offset:0 nt lds
    s_waitcnt vmcnt(20)
    buffer_load_dwordx4 v29, s[28:31], s62 offen offset:1056 nt lds
    s_waitcnt vmcnt(20)
    buffer_load_dwordx4 v30, s[28:31], s62 offen offset:2112 nt lds
    s_waitcnt vmcnt(20)
    buffer_load_dwordx4 v31, s[28:31], s62 offen offset:3168 nt lds
    s_add_u32 m0, s54, 12672
    s_waitcnt vmcnt(20)
    buffer_load_dwordx4 v28, s[28:31], s63 offen offset:0 nt lds
    s_waitcnt vmcnt(20)
    buffer_load_dwordx4 v29, s[28:31], s63 offen offset:1056 nt lds
    s_waitcnt vmcnt(20)
    buffer_load_dwordx4 v30, s[28:31], s63 offen offset:2112 nt lds
    s_waitcnt vmcnt(20)
    buffer_load_dwordx4 v31, s[28:31], s63 offen offset:3168 nt lds
    s_branch L_drain
L_pro22:
    s_mov_b32 m0, 8704
    s_nop 0
    buffer_load_dwordx4 v24, s[24:27], s62 offen offset:0 nt lds
    buffer_load_dwordx4 v25, s[24:27], s62 offen offset:1088 nt lds
    buffer_load_dwordx4 v26, s[24:27], s62 offen offset:2176 nt lds
    buffer_load_dwordx4 v27, s[24:27], s62 offen offset:3264 nt lds
    s_mov_b32 m0, 13056
    s_nop 0
    buffer_load_dwordx4 v24, s[24:27], s63 offen offset:0 nt lds
    buffer_load_dwordx4 v25, s[24:27], s63 offen offset:1088 nt lds
    buffer_load_dwordx4 v26, s[24:27], s63 offen offset:2176 nt lds
    buffer_load_dwordx4 v27, s[24:27], s63 offen offset:3264 nt lds
    s_mov_b32 s53, 17408
    s_cmp_ge_u32 s50, s51
    s_cbranch_scc1 L_tail22
    s_mov_b32 m0, 17408
    s_nop 0
    buffer_load_dwordx4 v24, s[24:27], s56 offen offset:0 nt lds
    buffer_load_dwordx4 v25, s[24:27], s56 offen offset:1088 nt lds
    buffer_load_dwordx4 v26, s[24:27], s56 offen offset:2176 nt lds
    buffer_load_dwordx4 v27, s[24:27], s56 offen offset:3264 nt lds
    s_branch L_mid22
L_loop22:
    s_sub_i32 s48, s50, 3
    s_branch L_fchka22
L_fspina22:
    ds_read_b128 v[32:35], v36
L_fchka22:
    s_waitcnt lgkmcnt(0)
    v_min_u32 v32, v32, v33
    v_min3_u32 v32, v32, v34, v35
    s_nop 0
    v_readfirstlane_b32 s47, v32
    s_nop 0
    s_cmp_ge_i32 s47, s48
    s_cbranch_scc0 L_fspina22
    s_add_u32 m0, s53, 0
    s_waitcnt vmcnt(21)
    buffer_load_dwordx4 v24, s[24:27], s56 offen offset:0 nt lds
    s_waitcnt vmcnt(21)
    buffer_load_dwordx4 v25, s[24:27], s56 offen offset:1088 nt lds
    s_waitcnt vmcnt(21)
    buffer_load_dwordx4 v26, s[24:27], s56 offen offset:2176 nt lds
    s_waitcnt vmcnt(21)
    buffer_load_dwordx4 v27, s[24:27], s56 offen offset:3264 nt lds
L_mid22:
    s_add_u32 m0, s53, 4352
    s_waitcnt vmcnt(21)
    buffer_load_dwordx4 v24, s[24:27], s57 offen offset:0 nt lds
    s_waitcnt vmcnt(21)
    s_cmp_ge_u32 s50, 2
    s_cbranch_scc0 L_nbka22
    s_lshl1_add_u32 s52, s50, -2
    v_mov_b32 v37, s52
    ds_write_b32 v36, v37 offset:16
L_nbka22:
    buffer_load_dwordx4 v25, s[24:27], s57 offen offset:1088 nt lds
    s_waitcnt vmcnt(21)
    buffer_load_dwordx4 v26, s[24:27], s57 offen offset:2176 nt lds
    s_waitcnt vmcnt(21)
    buffer_load_dwordx4 v27, s[24:27], s57 offen offset:3264 nt lds
    s_add_u32 m0, s53, 8704
    s_waitcnt vmcnt(21)
    buffer_load_dwordx4 v24, s[24:27], s58 offen offset:0 nt lds
    s_waitcnt vmcnt(21)
    buffer_load_dwordx4 v25, s[24:27], s58 offen offset:1088 nt lds
    s_waitcnt vmcnt(21)
    buffer_load_dwordx4 v26, s[24:27], s58 offen offset:2176 nt lds
    s_waitcnt vmcnt(21)
    buffer_load_dwordx4 v27, s[24:27], s58 offen offset:3264 nt lds
    s_add_u32 m0, s53, 13056
    s_waitcnt vmcnt(21)
    buffer_load_dwordx4 v24, s[24:27], s59 offen offset:0 nt lds
    s_waitcnt vmcnt(21)
    buffer_load_dwordx4 v25, s[24:27], s59 offen offset:1088 nt lds
    s_waitcnt vmcnt(21)
    buffer_load_dwordx4 v26, s[24:27], s59 offen offset:2176 nt lds
    s_waitcnt vmcnt(21)
    buffer_load_dwordx4 v27, s[24:27], s59 offen offset:3264 nt lds
    s_add_u32 m0, s54, 0
    s_waitcnt vmcnt(21)
    buffer_load_dwordx4 v28, s[28:31], s60 offen offset:0 nt lds
    s_waitcnt vmcnt(21)
    buffer_load_dwordx4 v29, s[28:31], s60 offen offset:1056 nt lds
    s_waitcnt vmcnt(21)
    buffer_load_dwordx4 v30, s[28:31], s60 offen offset:2112 nt lds
    s_waitcnt vmcnt(21)
    buffer_load_dwordx4 v31, s[28:31], s60 offen offset:3168 nt lds
    s_add_u32 m0, s54, 4224
    s_waitcnt vmcnt(21)
    buffer_load_dwordx4 v28, s[28:31], s61 offen offset:0 nt lds
    s_waitcnt vmcnt(21)
    s_lshl1_add_u32 s52, s50, -1
    v_mov_b32 v37, s52
    ds_write_b32 v36, v37 offset:16
    buffer_load_dwordx4 v29, s[28:31], s61 offen offset:1056 nt lds
    s_waitcnt vmcnt(21)
    buffer_load_dwordx4 v30, s[28:31], s61 offen offset:2112 nt lds
    s_waitcnt vmcnt(21)
    buffer_load_dwordx4 v31, s[28:31], s61 offen offset:3168 nt lds
    s_add_u32 m0, s54, 8448
    s_waitcnt vmcnt(21)
    buffer_load_dwordx4 v28, s[28:31], s62 offen offset:0 nt lds
    s_waitcnt vmcnt(21)
    buffer_load_dwordx4 v29, s[28:31], s62 offen offset:1056 nt lds
    s_waitcnt vmcnt(21)
    buffer_load_dwordx4 v30, s[28:31], s62 offen offset:2112 nt lds
    s_waitcnt vmcnt(21)
    ds_read_b128 v[32:35], v36
    buffer_load_dwordx4 v31, s[28:31], s62 offen offset:3168 nt lds
    s_add_u32 m0, s54, 12672
    s_waitcnt vmcnt(21)
    buffer_load_dwordx4 v28, s[28:31], s63 offen offset:0 nt lds
    s_waitcnt vmcnt(21)
    buffer_load_dwordx4 v29, s[28:31], s63 offen offset:1056 nt lds
    s_waitcnt vmcnt(21)
    buffer_load_dwordx4 v30, s[28:31], s63 offen offset:2112 nt lds
    s_waitcnt vmcnt(21)
    buffer_load_dwordx4 v31, s[28:31], s63 offen offset:3168 nt lds
    s_add_u32 s50, s50, 1
    s_mov_b64 s[60:61], s[56:57]
    s_mov_b64 s[62:63], s[58:59]
    s_cmp_eq_u32 s50, 2
    s_cbranch_scc0 L_tab22
L_tw22:
    ds_read_b128 v[40:43], v36 offset:32
    ds_read_b128 v[20:23], v39
    s_waitcnt lgkmcnt(0)
    v_min3_u32 v40, v40, v41, v42
    v_min_u32 v40, v40, v43
    s_nop 0
    v_readfirstlane_b32 s47, v40
    s_nop 0
    s_cmp_eq_u32 s47, 0
    s_cbranch_scc1 L_tw22
L_tab22:
    v_readlane_b32 s56, v20, s50
    v_readlane_b32 s57, v21, s50
    v_readlane_b32 s58, v22, s50
    v_readlane_b32 s59, v23, s50
    s_add_u32 s53, s53, 17408
    s_cmp_ge_u32 s53, 69632
    s_cselect_b32 s53, 0, s53
    s_add_u32 s54, s54, 16896
    s_cmp_ge_u32 s54, 137216
    s_cselect_b32 s54, 69632, s54
    s_cmp_lt_u32 s50, s51
    s_cbranch_scc1 L_loop22
L_tail22:
    s_sub_i32 s48, s50, 3
    s_branch L_fchkb22
L_fspinb22:
    ds_read_b128 v[32:35], v36
L_fchkb22:
    s_waitcnt lgkmcnt(0)
    v_min_u32 v32, v32, v33
    v_min3_u32 v32, v32, v34, v35
    s_nop 0
    v_readfirstlane_b32 s47, v32
    s_nop 0
    s_cmp_ge_i32 s47, s48
    s_cbranch_scc0 L_fspinb22
    s_add_u32 m0, s54, 0
    s_waitcnt vmcnt(21)
    buffer_load_dwordx4 v28, s[28:31], s60 offen offset:0 nt lds
    s_waitcnt vmcnt(21)
    buffer_load_dwordx4 v29, s[28:31], s60 offen offset:1056 nt lds
    s_waitcnt vmcnt(21)
    buffer_load_dwordx4 v30, s[28:31], s60 offen offset:2112 nt lds
    s_waitcnt vmcnt(21)
    buffer_load_dwordx4 v31, s[28:31], s60 offen offset:3168 nt lds
    s_add_u32 m0, s54, 4224
    s_waitcnt vmcnt(21)
    buffer_load_dwordx4 v28, s[28:31], s61 offen offset:0 nt lds
    s_waitcnt vmcnt(21)
    s_cmp_ge_u32 s50, 2
    s_cbranch_scc0 L_nbkb22
    s_lshl1_add_u32 s52, s50, -2
    v_mov_b32 v37, s52
    ds_write_b32 v36, v37 offset:16
L_nbkb22:
    buffer_load_dwordx4 v29, s[28:31], s61 offen offset:1056 nt lds
    s_waitcnt vmcnt(21)
    buffer_load_dwordx4 v30, s[28:31], s61 offen offset:2112 nt lds
    s_waitcnt vmcnt(21)
    buffer_load_dwordx4 v31, s[28:31], s61 offen offset:3168 nt lds
    s_add_u32 m0, s54, 8448
    s_waitcnt vmcnt(21)
    buffer_load_dwordx4 v28, s[28:31], s62 offen offset:0 nt lds
    s_waitcnt vmcnt(21)
    buffer_load_dwordx4 v29, s[28:31], s62 offen offset:1056 nt lds
    s_waitcnt vmcnt(21)
    buffer_load_dwordx4 v30, s[28:31], s62 offen offset:2112 nt lds
    s_waitcnt vmcnt(21)
    buffer_load_dwordx4 v31, s[28:31], s62 offen offset:3168 nt lds
    s_add_u32 m0, s54, 12672
    s_waitcnt vmcnt(21)
    buffer_load_dwordx4 v28, s[28:31], s63 offen offset:0 nt lds
    s_waitcnt vmcnt(21)
    buffer_load_dwordx4 v29, s[28:31], s63 offen offset:1056 nt lds
    s_waitcnt vmcnt(21)
    buffer_load_dwordx4 v30, s[28:31], s63 offen offset:2112 nt lds
    s_waitcnt vmcnt(21)
    buffer_load_dwordx4 v31, s[28:31], s63 offen offset:3168 nt lds
    s_branch L_drain
L_pro23:
    s_mov_b32 m0, 8704
    s_nop 0
    buffer_load_dwordx4 v24, s[24:27], s62 offen offset:0 nt lds
    buffer_load_dwordx4 v25, s[24:27], s62 offen offset:1088 nt lds
    buffer_load_dwordx4 v26, s[24:27], s62 offen offset:2176 nt lds
    buffer_load_dwordx4 v27, s[24:27], s62 offen offset:3264 nt lds
    s_mov_b32 m0, 13056
    s_nop 0
    buffer_load_dwordx4 v24, s[24:27], s63 offen offset:0 nt lds
    buffer_load_dwordx4 v25, s[24:27], s63 offen offset:1088 nt lds
    buffer_load_dwordx4 v26, s[24:27], s63 offen offset:2176 nt lds
    buffer_load_dwordx4 v27, s[24:27], s63 offen offset:3264 nt lds
    s_mov_b32 s53, 17408
    s_cmp_ge_u32 s50, s51
    s_cbranch_scc1 L_tail23
    s_mov_b32 m0, 17408
    s_nop 0
    buffer_load_dwordx4 v24, s[24:27], s56 offen offset:0 nt lds
    buffer_load_dwordx4 v25, s[24:27], s56 offen offset:1088 nt lds
    buffer_load_dwordx4 v26, s[24:27], s56 offen offset:2176 nt lds
    buffer_load_dwordx4 v27, s[24:27], s56 offen offset:3264 nt lds
    s_branch L_mid23
L_loop23:
    s_sub_i32 s48, s50, 3
    s_branch L_fchka23
L_fspina23:
    ds_read_b128 v[32:35], v36
L_fchka23:
    s_waitcnt lgkmcnt(0)
    v_min_u32 v32, v32, v33
    v_min3_u32 v32, v32, v34, v35
    s_nop 0
    v_readfirstlane_b32 s47, v32
    s_nop 0
    s_cmp_ge_i32 s47, s48
    s_cbranch_scc0 L_fspina23
    s_add_u32 m0, s53, 0
    s_waitcnt vmcnt(22)
    buffer_load_dwordx4 v24, s[24:27], s56 offen offset:0 nt lds
    s_waitcnt vmcnt(22)
    buffer_load_dwordx4 v25, s[24:27], s56 offen offset:1088 nt lds
    s_waitcnt vmcnt(22)
    buffer_load_dwordx4 v26, s[24:27], s56 offen offset:2176 nt lds
    s_waitcnt vmcnt(22)
    buffer_load_dwordx4 v27, s[24:27], s56 offen offset:3264 nt lds
L_mid23:
    s_add_u32 m0, s53, 4352
    s_waitcnt vmcnt(22)
    buffer_load_dwordx4 v24, s[24:27], s57 offen offset:0 nt lds
    s_waitcnt vmcnt(22)
    buffer_load_dwordx4 v25, s[24:27], s57 offen offset:1088 nt lds
    s_waitcnt vmcnt(22)
    s_cmp_ge_u32 s50, 2
    s_cbranch_scc0 L_nbka23
    s_lshl1_add_u32 s52, s50, -2
    v_mov_b32 v37, s52
    ds_write_b32 v36, v37 offset:16
L_nbka23:
    buffer_load_dwordx4 v26, s[24:27], s57 offen offset:2176 nt lds
    s_waitcnt vmcnt(22)
    buffer_load_dwordx4 v27, s[24:27], s57 offen offset:3264 nt lds
    s_add_u32 m0, s53, 8704
    s_waitcnt vmcnt(22)
    buffer_load_dwordx4 v24, s[24:27], s58 offen offset:0 nt lds
    s_waitcnt vmcnt(22)
    buffer_load_dwordx4 v25, s[24:27], s58 offen offset:1088 nt lds
    s_waitcnt vmcnt(22)
    buffer_load_dwordx4 v26, s[24:27], s58 offen offset:2176 nt lds
    s_waitcnt vmcnt(22)
    buffer_load_dwordx4 v27, s[24:27], s58 offen offset:3264 nt lds
    s_add_u32 m0, s53, 13056
    s_waitcnt vmcnt(22)
    buffer_load_dwordx4 v24, s[24:27], s59 offen offset:0 nt lds
    s_waitcnt vmcnt(22)
    buffer_load_dwordx4 v25, s[24:27], s59 offen offset:1088 nt lds
    s_waitcnt vmcnt(22)
    buffer_load_dwordx4 v26, s[24:27], s59 offen offset:2176 nt lds
    s_waitcnt vmcnt(22)
    buffer_load_dwordx4 v27, s[24:27], s59 offen offset:3264 nt lds
    s_add_u32 m0, s54, 0
    s_waitcnt vmcnt(22)
    buffer_load_dwordx4 v28, s[28:31], s60 offen offset:0 nt lds
    s_waitcnt vmcnt(22)
    buffer_load_dwordx4 v29, s[28:31], s60 offen offset:1056 nt lds
    s_waitcnt vmcnt(22)
    buffer_load_dwordx4 v30, s[28:31], s60 offen offset:2112 nt lds
    s_waitcnt vmcnt(22)
    buffer_load_dwordx4 v31, s[28:31], s60 offen offset:3168 nt lds
    s_add_u32 m0, s54, 4224
    s_waitcnt vmcnt(22)
    buffer_load_dwordx4 v28, s[28:31], s61 offen offset:0 nt lds
    s_waitcnt vmcnt(22)
    buffer_load_dwordx4 v29, s[28:31], s61 offen offset:1056 nt lds
    s_waitcnt vmcnt(22)
    s_lshl1_add_u32 s52, s50, -1
    v_mov_b32 v37, s52
    ds_write_b32 v36, v37 offset:16
    buffer_load_dwordx4 v30, s[28:31], s61 offen offset:2112 nt lds
    s_waitcnt vmcnt(22)
    buffer_load_dwordx4 v31, s[28:31], s61 offen offset:3168 nt lds
    s_add_u32 m0, s54, 8448
    s_waitcnt vmcnt(22)
    buffer_load_dwordx4 v28, s[28:31], s62 offen offset:0 nt lds
    s_waitcnt vmcnt(22)
    buffer_load_dwordx4 v29, s[28:31], s62 offen offset:1056 nt lds
    s_waitcnt vmcnt(22)
    buffer_load_dwordx4 v30, s[28:31], s62 offen offset:2112 nt lds
    s_waitcnt vmcnt(22)
    ds_read_b128 v[32:35], v36
    buffer_load_dwordx4 v31, s[28:31], s62 offen offset:3168 nt lds
    s_add_u32 m0, s54, 12672
    s_waitcnt vmcnt(22)
    buffer_load_dwordx4 v28, s[28:31], s63 offen offset:0 nt lds
    s_waitcnt vmcnt(22)
    buffer_load_dwordx4 v29, s[28:31], s63 offen offset:1056 nt lds
    s_waitcnt vmcnt(22)
    buffer_load_dwordx4 v30, s[28:31], s63 offen offset:2112 nt lds
    s_waitcnt vmcnt(22)
    buffer_load_dwordx4 v31, s[28:31], s63 offen offset:3168 nt lds
    s_add_u32 s50, s50, 1
    s_mov_b64 s[60:61], s[56:57]
    s_mov_b64 s[62:63], s[58:59]
    s_cmp_eq_u32 s50, 2
    s_cbranch_scc0 L_tab23
L_tw23:
    ds_read_b128 v[40:43], v36 offset:32
    ds_read_b128 v[20:23], v39
    s_waitcnt lgkmcnt(0)
    v_min3_u32 v40, v40, v41, v42
    v_min_u32 v40, v40, v43
    s_nop 0
    v_readfirstlane_b32 s47, v40
    s_nop 0
    s_cmp_eq_u32 s47, 0
    s_cbranch_scc1 L_tw23
L_tab23:
    v_readlane_b32 s56, v20, s50
    v_readlane_b32 s57, v21, s50
    v_readlane_b32 s58, v22, s50
    v_readlane_b32 s59, v23, s50
    s_add_u32 s53, s53, 17408
    s_cmp_ge_u32 s53, 69632
    s_cselect_b32 s53, 0, s53
    s_add_u32 s54, s54, 16896
    s_cmp_ge_u32 s54, 137216
    s_cselect_b32 s54, 69632, s54
    s_cmp_lt_u32 s50, s51
    s_cbranch_scc1 L_loop23
L_tail23:
    s_sub_i32 s48, s50, 3
    s_branch L_fchkb23
L_fspinb23:
    ds_read_b128 v[32:35], v36
L_fchkb23:
    s_waitcnt lgkmcnt(0)
    v_min_u32 v32, v32, v33
    v_min3_u32 v32, v32, v34, v35
    s_nop 0
    v_readfirstlane_b32 s47, v32
    s_nop 0
    s_cmp_ge_i32 s47, s48
    s_cbranch_scc0 L_fspinb23
    s_add_u32 m0, s54, 0
    s_waitcnt vmcnt(22)
    buffer_load_dwordx4 v28, s[28:31], s60 offen offset:0 nt lds
    s_waitcnt vmcnt(22)
    buffer_load_dwordx4 v29, s[28:31], s60 offen offset:1056 nt lds
    s_waitcnt vmcnt(22)
    buffer_load_dwordx4 v30, s[28:31], s60 offen offset:2112 nt lds
    s_waitcnt vmcnt(22)
    buffer_load_dwordx4 v31, s[28:31], s60 offen offset:3168 nt lds
    s_add_u32 m0, s54, 4224
    s_waitcnt vmcnt(22)
    buffer_load_dwordx4 v28, s[28:31], s61 offen offset:0 nt lds
    s_waitcnt vmcnt(22)
    buffer_load_dwordx4 v29, s[28:31], s61 offen offset:1056 nt lds
    s_waitcnt vmcnt(22)
    s_cmp_ge_u32 s50, 2
    s_cbranch_scc0 L_nbkb23
    s_lshl1_add_u32 s52, s50, -2
    v_mov_b32 v37, s52
    ds_write_b32 v36, v37 offset:16
L_nbkb23:
    buffer_load_dwordx4 v30, s[28:31], s61 offen offset:2112 nt lds
    s_waitcnt vmcnt(22)
    buffer_load_dwordx4 v31, s[28:31], s61 offen offset:3168 nt lds
    s_add_u32 m0, s54, 8448
    s_waitcnt vmcnt(22)
    buffer_load_dwordx4 v28, s[28:31], s62 offen offset:0 nt lds
    s_waitcnt vmcnt(22)
    buffer_load_dwordx4 v29, s[28:31], s62 offen offset:1056 nt lds
    s_waitcnt vmcnt(22)
    buffer_load_dwordx4 v30, s[28:31], s62 offen offset:2112 nt lds
    s_waitcnt vmcnt(22)
    buffer_load_dwordx4 v31, s[28:31], s62 offen offset:3168 nt lds
    s_add_u32 m0, s54, 12672
    s_waitcnt vmcnt(22)
    buffer_load_dwordx4 v28, s[28:31], s63 offen offset:0 nt lds
    s_waitcnt vmcnt(22)
    buffer_load_dwordx4 v29, s[28:31], s63 offen offset:1056 nt lds
    s_waitcnt vmcnt(22)
    buffer_load_dwordx4 v30, s[28:31], s63 offen offset:2112 nt lds
    s_waitcnt vmcnt(22)
    buffer_load_dwordx4 v31, s[28:31], s63 offen offset:3168 nt lds
    s_branch L_drain
L_pro24:
    s_mov_b32 m0, 8704
    s_nop 0
    buffer_load_dwordx4 v24, s[24:27], s62 offen offset:0 nt lds
    buffer_load_dwordx4 v25, s[24:27], s62 offen offset:1088 nt lds
    buffer_load_dwordx4 v26, s[24:27], s62 offen offset:2176 nt lds
    buffer_load_dwordx4 v27, s[24:27], s62 offen offset:3264 nt lds
    s_mov_b32 m0, 13056
    s_nop 0
    buffer_load_dwordx4 v24, s[24:27], s63 offen offset:0 nt lds
    buffer_load_dwordx4 v25, s[24:27], s63 offen offset:1088 nt lds
    buffer_load_dwordx4 v26, s[24:27], s63 offen offset:2176 nt lds
    buffer_load_dwordx4 v27, s[24:27], s63 offen offset:3264 nt lds
    s_mov_b32 s53, 17408
    s_cmp_ge_u32 s50, s51
    s_cbranch_scc1 L_tail24
    s_mov_b32 m0, 17408
    s_nop 0
    buffer_load_dwordx4 v24, s[24:27], s56 offen offset:0 nt lds
    buffer_load_dwordx4 v25, s[24:27], s56 offen offset:1088 nt lds
    buffer_load_dwordx4 v26, s[24:27], s56 offen offset:2176 nt lds
    buffer_load_dwordx4 v27, s[24:27], s56 offen offset:3264 nt lds
    s_mov_b32 m0, 21760
    s_nop 0
    buffer_load_dwordx4 v24, s[24:27], s57 offen offset:0 nt lds
    buffer_load_dwordx4 v25, s[24:27], s57 offen offset:1088 nt lds
    buffer_load_dwordx4 v26, s[24:27], s57 offen offset:2176 nt lds
    buffer_load_dwordx4 v27, s[24:27], s57 offen offset:3264 nt lds
    s_branch L_mid24
L_loop24:
    s_sub_i32 s48, s50, 3
    s_branch L_fchka24
L_fspina24:
    ds_read_b128 v[32:35], v36
L_fchka24:
    s_waitcnt lgkmcnt(0)
    v_min_u32 v32, v32, v33
    v_min3_u32 v32, v32, v34, v35
    s_nop 0
    v_readfirstlane_b32 s47, v32
    s_nop 0
    s_cmp_ge_i32 s47, s48
    s_cbranch_scc0 L_fspina24
    s_add_u32 m0, s53, 0
    s_waitcnt vmcnt(23)
    buffer_load_dwordx4 v24, s[24:27], s56 offen offset:0 nt lds
    s_waitcnt vmcnt(23)
    buffer_load_dwordx4 v25, s[24:27], s56 offen offset:1088 nt lds
    s_waitcnt vmcnt(23)
    buffer_load_dwordx4 v26, s[24:27], s56 offen offset:2176 nt lds
    s_waitcnt vmcnt(23)
    buffer_load_dwordx4 v27, s[24:27], s56 offen offset:3264 nt lds
    s_add_u32 m0, s53, 4352
    s_waitcnt vmcnt(23)
    buffer_load_dwordx4 v24, s[24:27], s57 offen offset:0 nt lds
    s_waitcnt vmcnt(23)
    buffer_load_dwordx4 v25, s[24:27], s57 offen offset:1088 nt lds
    s_waitcnt vmcnt(23)
    buffer_load_dwordx4 v26, s[24:27], s57 offen offset:2176 nt lds
    s_waitcnt vmcnt(23)
    s_cmp_ge_u32 s50, 2
    s_cbranch_scc0 L_nbka24
    s_lshl1_add_u32 s52, s50, -2
    v_mov_b32 v37, s52
    ds_write_b32 v36, v37 offset:16
L_nbka24:
    buffer_load_dwordx4 v27, s[24:27], s57 offen offset:3264 nt lds
L_mid24:
    s_add_u32 m0, s53, 8704
    s_waitcnt vmcnt(23)
    buffer_load_dwordx4 v24, s[24:27], s58 offen offset:0 nt lds
    s_waitcnt vmcnt(23)
    buffer_load_dwordx4 v25, s[24:27], s58 offen offset:1088 nt lds
    s_waitcnt vmcnt(23)
    buffer_load_dwordx4 v26, s[24:27], s58 offen offset:2176 nt lds
    s_waitcnt vmcnt(23)
    buffer_load_dwordx4 v27, s[24:27], s58 offen offset:3264 nt lds
    s_add_u32 m0, s53, 13056
    s_waitcnt vmcnt(23)
    buffer_load_dwordx4 v24, s[24:27], s59 offen offset:0 nt lds
    s_waitcnt vmcnt(23)
    buffer_load_dwordx4 v25, s[24:27], s59 offen offset:1088 nt lds
    s_waitcnt vmcnt(23)
    buffer_load_dwordx4 v26, s[24:27], s59 offen offset:2176 nt lds
    s_waitcnt vmcnt(23)
    buffer_load_dwordx4 v27, s[24:27], s59 offen offset:3264 nt lds
    s_add_u32 m0, s54, 0
    s_waitcnt vmcnt(23)
    buffer_load_dwordx4 v28, s[28:31], s60 offen offset:0 nt lds
    s_waitcnt vmcnt(23)
    buffer_load_dwordx4 v29, s[28:31], s60 offen offset:1056 nt lds
    s_waitcnt vmcnt(23)
    buffer_load_dwordx4 v30, s[28:31], s60 offen offset:2112 nt lds
    s_waitcnt vmcnt(23)
    buffer_load_dwordx4 v31, s[28:31], s60 offen offset:3168 nt lds
    s_add_u32 m0, s54, 4224
    s_waitcnt vmcnt(23)
    buffer_load_dwordx4 v28, s[28:31], s61 offen offset:0 nt lds
    s_waitcnt vmcnt(23)
    buffer_load_dwordx4 v29, s[28:31], s61 offen offset:1056 nt lds
    s_waitcnt vmcnt(23)
    buffer_load_dwordx4 v30, s[28:31], s61 offen offset:2112 nt lds
    s_waitcnt vmcnt(23)
    s_lshl1_add_u32 s52, s50, -1
    v_mov_b32 v37, s52
    ds_write_b32 v36, v37 offset:16
    buffer_load_dwordx4 v31, s[28:31], s61 offen offset:3168 nt lds
    s_add_u32 m0, s54, 8448
    s_waitcnt vmcnt(23)
    buffer_load_dwordx4 v28, s[28:31], s62 offen offset:0 nt lds
    s_waitcnt vmcnt(23)
    buffer_load_dwordx4 v29, s[28:31], s62 offen offset:1056 nt lds
    s_waitcnt vmcnt(23)
    buffer_load_dwordx4 v30, s[28:31], s62 offen offset:2112 nt lds
    s_waitcnt vmcnt(23)
    ds_read_b128 v[32:35], v36
    buffer_load_dwordx4 v31, s[28:31], s62 offen offset:3168 nt lds
    s_add_u32 m0, s54, 12672
    s_waitcnt vmcnt(23)
    buffer_load_dwordx4 v28, s[28:31], s63 offen offset:0 nt lds
    s_waitcnt vmcnt(23)
    buffer_load_dwordx4 v29, s[28:31], s63 offen offset:1056 nt lds
    s_waitcnt vmcnt(23)
    buffer_load_dwordx4 v30, s[28:31], s63 offen offset:2112 nt lds
    s_waitcnt vmcnt(23)
    buffer_load_dwordx4 v31, s[28:31], s63 offen offset:3168 nt lds
    s_add_u32 s50, s50, 1
    s_mov_b64 s[60:61], s[56:57]
    s_mov_b64 s[62:63], s[58:59]
    s_cmp_eq_u32 s50, 2
    s_cbranch_scc0 L_tab24
L_tw24:
    ds_read_b128 v[40:43], v36 offset:32
    ds_read_b128 v[20:23], v39
    s_waitcnt lgkmcnt(0)
    v_min3_u32 v40, v40, v41, v42
    v_min_u32 v40, v40, v43
    s_nop 0
    v_readfirstlane_b32 s47, v40
    s_nop 0
    s_cmp_eq_u32 s47, 0
    s_cbranch_scc1 L_tw24
L_tab24:
    v_readlane_b32 s56, v20, s50
    v_readlane_b32 s57, v21, s50
    v_readlane_b32 s58, v22, s50
    v_readlane_b32 s59, v23, s50
    s_add_u32 s53, s53, 17408
    s_cmp_ge_u32 s53, 69632
    s_cselect_b32 s53, 0, s53
    s_add_u32 s54, s54, 16896
    s_cmp_ge_u32 s54, 137216
    s_cselect_b32 s54, 69632, s54
    s_cmp_lt_u32 s50, s51
    s_cbranch_scc1 L_loop24
L_tail24:
    s_sub_i32 s48, s50, 3
    s_branch L_fchkb24
L_fspinb24:
    ds_read_b128 v[32:35], v36
L_fchkb24:
    s_waitcnt lgkmcnt(0)
    v_min_u32 v32, v32, v33
    v_min3_u32 v32, v32, v34, v35
    s_nop 0
    v_readfirstlane_b32 s47, v32
    s_nop 0
    s_cmp_ge_i32 s47, s48
    s_cbranch_scc0 L_fspinb24
    s_add_u32 m0, s54, 0
    s_waitcnt vmcnt(23)
    buffer_load_dwordx4 v28, s[28:31], s60 offen offset:0 nt lds
    s_waitcnt vmcnt(23)
    buffer_load_dwordx4 v29, s[28:31], s60 offen offset:1056 nt lds
    s_waitcnt vmcnt(23)
    buffer_load_dwordx4 v30, s[28:31], s60 offen offset:2112 nt lds
    s_waitcnt vmcnt(23)
    buffer_load_dwordx4 v31, s[28:31], s60 offen offset:3168 nt lds
    s_add_u32 m0, s54, 4224
    s_waitcnt vmcnt(23)
    buffer_load_dwordx4 v28, s[28:31], s61 offen offset:0 nt lds
    s_waitcnt vmcnt(23)
    buffer_load_dwordx4 v29, s[28:31], s61 offen offset:1056 nt lds
    s_waitcnt vmcnt(23)
    buffer_load_dwordx4 v30, s[28:31], s61 offen offset:2112 nt lds
    s_waitcnt vmcnt(23)
    s_cmp_ge_u32 s50, 2
    s_cbranch_scc0 L_nbkb24
    s_lshl1_add_u32 s52, s50, -2
    v_mov_b32 v37, s52
    ds_write_b32 v36, v37 offset:16
L_nbkb24:
    buffer_load_dwordx4 v31, s[28:31], s61 offen offset:3168 nt lds
    s_add_u32 m0, s54, 8448
    s_waitcnt vmcnt(23)
    buffer_load_dwordx4 v28, s[28:31], s62 offen offset:0 nt lds
    s_waitcnt vmcnt(23)
    buffer_load_dwordx4 v29, s[28:31], s62 offen offset:1056 nt lds
    s_waitcnt vmcnt(23)
    buffer_load_dwordx4 v30, s[28:31], s62 offen offset:2112 nt lds
    s_waitcnt vmcnt(23)
    buffer_load_dwordx4 v31, s[28:31], s62 offen offset:3168 nt lds
    s_add_u32 m0, s54, 12672
    s_waitcnt vmcnt(23)
    buffer_load_dwordx4 v28, s[28:31], s63 offen offset:0 nt lds
    s_waitcnt vmcnt(23)
    buffer_load_dwordx4 v29, s[28:31], s63 offen offset:1056 nt lds
    s_waitcnt vmcnt(23)
    buffer_load_dwordx4 v30, s[28:31], s63 offen offset:2112 nt lds
    s_waitcnt vmcnt(23)
    buffer_load_dwordx4 v31, s[28:31], s63 offen offset:3168 nt lds
    s_branch L_drain
L_pro25:
    s_mov_b32 m0, 8704
    s_nop 0
    buffer_load_dwordx4 v24, s[24:27], s62 offen offset:0 nt lds
    buffer_load_dwordx4 v25, s[24:27], s62 offen offset:1088 nt lds
    buffer_load_dwordx4 v26, s[24:27], s62 offen offset:2176 nt lds
    buffer_load_dwordx4 v27, s[24:27], s62 offen offset:3264 nt lds
    s_mov_b32 m0, 13056
    s_nop 0
    buffer_load_dwordx4 v24, s[24:27], s63 offen offset:0 nt lds
    buffer_load_dwordx4 v25, s[24:27], s63 offen offset:1088 nt lds
    buffer_load_dwordx4 v26, s[24:27], s63 offen offset:2176 nt lds
    buffer_load_dwordx4 v27, s[24:27], s63 offen offset:3264 nt lds
    s_mov_b32 s53, 17408
    s_cmp_ge_u32 s50, s51
    s_cbranch_scc1 L_tail25
    s_mov_b32 m0, 17408
    s_nop 0
    buffer_load_dwordx4 v24, s[24:27], s56 offen offset:0 nt lds
    buffer_load_dwordx4 v25, s[24:27], s56 offen offset:1088 nt lds
    buffer_load_dwordx4 v26, s[24:27], s56 offen offset:2176 nt lds
    buffer_load_dwordx4 v27, s[24:27], s56 offen offset:3264 nt lds
    s_mov_b32 m0, 21760
    s_nop 0
    buffer_load_dwordx4 v24, s[24:27], s57 offen offset:0 nt lds
    buffer_load_dwordx4 v25, s[24:27], s57 offen offset:1088 nt lds
    buffer_load_dwordx4 v26, s[24:27], s57 offen offset:2176 nt lds
    buffer_load_dwordx4 v27, s[24:27], s57 offen offset:3264 nt lds
    s_branch L_mid25
L_loop25:
    s_sub_i32 s48, s50, 3
    s_branch L_fchka25
L_fspina25:
    ds_read_b128 v[32:35], v36
L_fchka25:
    s_waitcnt lgkmcnt(0)
    v_min_u32 v32, v32, v33
    v_min3_u32 v32, v32, v34, v35
    s_nop 0
    v_readfirstlane_b32 s47, v32
    s_nop 0
    s_cmp_ge_i32 s47, s48
    s_cbranch_scc0 L_fspina25
    s_add_u32 m0, s53, 0
    s_waitcnt vmcnt(24)
    buffer_load_dwordx4 v24, s[24:27], s56 offen offset:0 nt lds
    s_waitcnt vmcnt(24)
    buffer_load_dwordx4 v25, s[24:27], s56 offen offset:1088 nt lds
    s_waitcnt vmcnt(24)
    buffer_load_dwordx4 v26, s[24:27], s56 offen offset:2176 nt lds
    s_waitcnt vmcnt(24)
    buffer_load_dwordx4 v27, s[24:27], s56 offen offset:3264 nt lds
    s_add_u32 m0, s53, 4352
    s_waitcnt vmcnt(24)
    buffer_load_dwordx4 v24, s[24:27], s57 offen offset:0 nt lds
    s_waitcnt vmcnt(24)
    buffer_load_dwordx4 v25, s[24:27], s57 offen offset:1088 nt lds
    s_waitcnt vmcnt(24)
    buffer_load_dwordx4 v26, s[24:27], s57 offen offset:2176 nt lds
    s_waitcnt vmcnt(24)
    buffer_load_dwordx4 v27, s[24:27], s57 offen offset:3264 nt lds
L_mid25:
    s_add_u32 m0, s53, 8704
    s_waitcnt vmcnt(24)
    s_cmp_ge_u32 s50, 2
    s_cbranch_scc0 L_nbka25
    s_lshl1_add_u32 s52, s50, -2
    v_mov_b32 v37, s52
    ds_write_b32 v36, v37 offset:16
L_nbka25:
    buffer_load_dwordx4 v24, s[24:27], s58 offen offset:0 nt lds
    s_waitcnt vmcnt(24)
    buffer_load_dwordx4 v25, s[24:27], s58 offen offset:1088 nt lds
    s_waitcnt vmcnt(24)
    buffer_load_dwordx4 v26, s[24:27], s58 offen offset:2176 nt lds
    s_waitcnt vmcnt(24)
    buffer_load_dwordx4 v27, s[24:27], s58 offen offset:3264 nt lds
    s_add_u32 m0, s53, 13056
    s_waitcnt vmcnt(24)
    buffer_load_dwordx4 v24, s[24:27], s59 offen offset:0 nt lds
    s_waitcnt vmcnt(24)
    buffer_load_dwordx4 v25, s[24:27], s59 offen offset:1088 nt lds
    s_waitcnt vmcnt(24)
    buffer_load_dwordx4 v26, s[24:27], s59 offen offset:2176 nt lds
    s_waitcnt vmcnt(24)
    buffer_load_dwordx4 v27, s[24:27], s59 offen offset:3264 nt lds
    s_add_u32 m0, s54, 0
    s_waitcnt vmcnt(24)
    buffer_load_dwordx4 v28, s[28:31], s60 offen offset:0 nt lds
    s_waitcnt vmcnt(24)
    buffer_load_dwordx4 v29, s[28:31], s60 offen offset:1056 nt lds
    s_waitcnt vmcnt(24)
    buffer_load_dwordx4 v30, s[28:31], s60 offen offset:2112 nt lds
    s_waitcnt vmcnt(24)
    buffer_load_dwordx4 v31, s[28:31], s60 offen offset:3168 nt lds
    s_add_u32 m0, s54, 4224
    s_waitcnt vmcnt(24)
    buffer_load_dwordx4 v28, s[28:31], s61 offen offset:0 nt lds
    s_waitcnt vmcnt(24)
    buffer_load_dwordx4 v29, s[28:31], s61 offen offset:1056 nt lds
    s_waitcnt vmcnt(24)
    buffer_load_dwordx4 v30, s[28:31], s61 offen offset:2112 nt lds
    s_waitcnt vmcnt(24)
    buffer_load_dwordx4 v31, s[28:31], s61 offen offset:3168 nt lds
    s_add_u32 m0, s54, 8448
    s_waitcnt vmcnt(24)
    s_lshl1_add_u32 s52, s50, -1
    v_mov_b32 v37, s52
    ds_write_b32 v36, v37 offset:16
    buffer_load_dwordx4 v28, s[28:31], s62 offen offset:0 nt lds
    s_waitcnt vmcnt(24)
    buffer_load_dwordx4 v29, s[28:31], s62 offen offset:1056 nt lds
    s_waitcnt vmcnt(24)
    buffer_load_dwordx4 v30, s[28:31], s62 offen offset:2112 nt lds
    s_waitcnt vmcnt(24)
    ds_read_b128 v[32:35], v36
    buffer_load_dwordx4 v31, s[28:31], s62 offen offset:3168 nt lds
    s_add_u32 m0, s54, 12672
    s_waitcnt vmcnt(24)
    buffer_load_dwordx4 v28, s[28:31], s63 offen offset:0 nt lds
    s_waitcnt vmcnt(24)
    buffer_load_dwordx4 v29, s[28:31], s63 offen offset:1056 nt lds
    s_waitcnt vmcnt(24)
    buffer_load_dwordx4 v30, s[28:31], s63 offen offset:2112 nt lds
    s_waitcnt vmcnt(24)
    buffer_load_dwordx4 v31, s[28:31], s63 offen offset:3168 nt lds
    s_add_u32 s50, s50, 1
    s_mov_b64 s[60:61], s[56:57]
    s_mov_b64 s[62:63], s[58:59]
    s_cmp_eq_u32 s50, 2
    s_cbranch_scc0 L_tab25
L_tw25:
    ds_read_b128 v[40:43], v36 offset:32
    ds_read_b128 v[20:23], v39
    s_waitcnt lgkmcnt(0)
    v_min3_u32 v40, v40, v41, v42
    v_min_u32 v40, v40, v43
    s_nop 0
    v_readfirstlane_b32 s47, v40
    s_nop 0
    s_cmp_eq_u32 s47, 0
    s_cbranch_scc1 L_tw25
L_tab25:
    v_readlane_b32 s56, v20, s50
    v_readlane_b32 s57, v21, s50
    v_readlane_b32 s58, v22, s50
    v_readlane_b32 s59, v23, s50
    s_add_u32 s53, s53, 17408
    s_cmp_ge_u32 s53, 69632
    s_cselect_b32 s53, 0, s53
    s_add_u32 s54, s54, 16896
    s_cmp_ge_u32 s54, 137216
    s_cselect_b32 s54, 69632, s54
    s_cmp_lt_u32 s50, s51
    s_cbranch_scc1 L_loop25
L_tail25:
    s_sub_i32 s48, s50, 3
    s_branch L_fchkb25
L_fspinb25:
    ds_read_b128 v[32:35], v36
L_fchkb25:
    s_waitcnt lgkmcnt(0)
    v_min_u32 v32, v32, v33
    v_min3_u32 v32, v32, v34, v35
    s_nop 0
    v_readfirstlane_b32 s47, v32
    s_nop 0
    s_cmp_ge_i32 s47, s48
    s_cbranch_scc0 L_fspinb25
    s_add_u32 m0, s54, 0
    s_waitcnt vmcnt(24)
    buffer_load_dwordx4 v28, s[28:31], s60 offen offset:0 nt lds
    s_waitcnt vmcnt(24)
    buffer_load_dwordx4 v29, s[28:31], s60 offen offset:1056 nt lds
    s_waitcnt vmcnt(24)
    buffer_load_dwordx4 v30, s[28:31], s60 offen offset:2112 nt lds
    s_waitcnt vmcnt(24)
    buffer_load_dwordx4 v31, s[28:31], s60 offen offset:3168 nt lds
    s_add_u32 m0, s54, 4224
    s_waitcnt vmcnt(24)
    buffer_load_dwordx4 v28, s[28:31], s61 offen offset:0 nt lds
    s_waitcnt vmcnt(24)
    buffer_load_dwordx4 v29, s[28:31], s61 offen offset:1056 nt lds
    s_waitcnt vmcnt(24)
    buffer_load_dwordx4 v30, s[28:31], s61 offen offset:2112 nt lds
    s_waitcnt vmcnt(24)
    buffer_load_dwordx4 v31, s[28:31], s61 offen offset:3168 nt lds
    s_add_u32 m0, s54, 8448
    s_waitcnt vmcnt(24)
    s_cmp_ge_u32 s50, 2
    s_cbranch_scc0 L_nbkb25
    s_lshl1_add_u32 s52, s50, -2
    v_mov_b32 v37, s52
    ds_write_b32 v36, v37 offset:16
L_nbkb25:
    buffer_load_dwordx4 v28, s[28:31], s62 offen offset:0 nt lds
    s_waitcnt vmcnt(24)
    buffer_load_dwordx4 v29, s[28:31], s62 offen offset:1056 nt lds
    s_waitcnt vmcnt(24)
    buffer_load_dwordx4 v30, s[28:31], s62 offen offset:2112 nt lds
    s_waitcnt vmcnt(24)
    buffer_load_dwordx4 v31, s[28:31], s62 offen offset:3168 nt lds
    s_add_u32 m0, s54, 12672
    s_waitcnt vmcnt(24)
    buffer_load_dwordx4 v28, s[28:31], s63 offen offset:0 nt lds
    s_waitcnt vmcnt(24)
    buffer_load_dwordx4 v29, s[28:31], s63 offen offset:1056 nt lds
    s_waitcnt vmcnt(24)
    buffer_load_dwordx4 v30, s[28:31], s63 offen offset:2112 nt lds
    s_waitcnt vmcnt(24)
    buffer_load_dwordx4 v31, s[28:31], s63 offen offset:3168 nt lds
    s_branch L_drain
L_pro26:
    s_mov_b32 m0, 8704
    s_nop 0
    buffer_load_dwordx4 v24, s[24:27], s62 offen offset:0 nt lds
    buffer_load_dwordx4 v25, s[24:27], s62 offen offset:1088 nt lds
    buffer_load_dwordx4 v26, s[24:27], s62 offen offset:2176 nt lds
    buffer_load_dwordx4 v27, s[24:27], s62 offen offset:3264 nt lds
    s_mov_b32 m0, 13056
    s_nop 0
    buffer_load_dwordx4 v24, s[24:27], s63 offen offset:0 nt lds
    buffer_load_dwordx4 v25, s[24:27], s63 offen offset:1088 nt lds
    buffer_load_dwordx4 v26, s[24:27], s63 offen offset:2176 nt lds
    buffer_load_dwordx4 v27, s[24:27], s63 offen offset:3264 nt lds
    s_mov_b32 s53, 17408
    s_cmp_ge_u32 s50, s51
    s_cbranch_scc1 L_tail26
    s_mov_b32 m0, 17408
    s_nop 0
    buffer_load_dwordx4 v24, s[24:27], s56 offen offset:0 nt lds
    buffer_load_dwordx4 v25, s[24:27], s56 offen offset:1088 nt lds
    buffer_load_dwordx4 v26, s[24:27], s56 offen offset:2176 nt lds
    buffer_load_dwordx4 v27, s[24:27], s56 offen offset:3264 nt lds
    s_mov_b32 m0, 21760
    s_nop 0
    buffer_load_dwordx4 v24, s[24:27], s57 offen offset:0 nt lds
    buffer_load_dwordx4 v25, s[24:27], s57 offen offset:1088 nt lds
    buffer_load_dwordx4 v26, s[24:27], s57 offen offset:2176 nt lds
    buffer_load_dwordx4 v27, s[24:27], s57 offen offset:3264 nt lds
    s_branch L_mid26
L_loop26:
    s_sub_i32 s48, s50, 3
    s_branch L_fchka26
L_fspina26:
    ds_read_b128 v[32:35], v36
L_fchka26:
    s_waitcnt lgkmcnt(0)
    v_min_u32 v32, v32, v33
    v_min3_u32 v32, v32, v34, v35
    s_nop 0
    v_readfirstlane_b32 s47, v32
    s_nop 0
    s_cmp_ge_i32 s47, s48
    s_cbranch_scc0 L_fspina26
    s_add_u32 m0, s53, 0
    s_waitcnt vmcnt(25)
    buffer_load_dwordx4 v24, s[24:27], s56 offen offset:0 nt lds
    s_waitcnt vmcnt(25)
    buffer_load_dwordx4 v25, s[24:27], s56 offen offset:1088 nt lds
    s_waitcnt vmcnt(25)
    buffer_load_dwordx4 v26, s[24:27], s56 offen offset:2176 nt lds
    s_waitcnt vmcnt(25)
    buffer_load_dwordx4 v27, s[24:27], s56 offen offset:3264 nt lds
    s_add_u32 m0, s53, 4352
    s_waitcnt vmcnt(25)
    buffer_load_dwordx4 v24, s[24:27], s57 offen offset:0 nt lds
    s_waitcnt vmcnt(25)
    buffer_load_dwordx4 v25, s[24:27], s57 offen offset:1088 nt lds
    s_waitcnt vmcnt(25)
    buffer_load_dwordx4 v26, s[24:27], s57 offen offset:2176 nt lds
    s_waitcnt vmcnt(25)
    buffer_load_dwordx4 v27, s[24:27], s57 offen offset:3264 nt lds
L_mid26:
    s_add_u32 m0, s53, 8704
    s_waitcnt vmcnt(25)
    buffer_load_dwordx4 v24, s[24:27], s58 offen offset:0 nt lds
    s_waitcnt vmcnt(25)
    s_cmp_ge_u32 s50, 2
    s_cbranch_scc0 L_nbka26
    s_lshl1_add_u32 s52, s50, -2
    v_mov_b32 v37, s52
    ds_write_b32 v36, v37 offset:16
L_nbka26:
    buffer_load_dwordx4 v25, s[24:27], s58 offen offset:1088 nt lds
    s_waitcnt vmcnt(25)
    buffer_load_dwordx4 v26, s[24:27], s58 offen offset:2176 nt lds
    s_waitcnt vmcnt(25)
    buffer_load_dwordx4 v27, s[24:27], s58 offen offset:3264 nt lds
    s_add_u32 m0, s53, 13056
    s_waitcnt vmcnt(25)
    buffer_load_dwordx4 v24, s[24:27], s59 offen offset:0 nt lds
    s_waitcnt vmcnt(25)
    buffer_load_dwordx4 v25, s[24:27], s59 offen offset:1088 nt lds
    s_waitcnt vmcnt(25)
    buffer_load_dwordx4 v26, s[24:27], s59 offen offset:2176 nt lds
    s_waitcnt vmcnt(25)
    buffer_load_dwordx4 v27, s[24:27], s59 offen offset:3264 nt lds
    s_add_u32 m0, s54, 0
    s_waitcnt vmcnt(25)
    buffer_load_dwordx4 v28, s[28:31], s60 offen offset:0 nt lds
    s_waitcnt vmcnt(25)
    buffer_load_dwordx4 v29, s[28:31], s60 offen offset:1056 nt lds
    s_waitcnt vmcnt(25)
    buffer_load_dwordx4 v30, s[28:31], s60 offen offset:2112 nt lds
    s_waitcnt vmcnt(25)
    buffer_load_dwordx4 v31, s[28:31], s60 offen offset:3168 nt lds
    s_add_u32 m0, s54, 4224
    s_waitcnt vmcnt(25)
    buffer_load_dwordx4 v28, s[28:31], s61 offen offset:0 nt lds
    s_waitcnt vmcnt(25)
    buffer_load_dwordx4 v29, s[28:31], s61 offen offset:1056 nt lds
    s_waitcnt vmcnt(25)
    buffer_load_dwordx4 v30, s[28:31], s61 offen offset:2112 nt lds
    s_waitcnt vmcnt(25)
    buffer_load_dwordx4 v31, s[28:31], s61 offen offset:3168 nt lds
    s_add_u32 m0, s54, 8448
    s_waitcnt vmcnt(25)
    buffer_load_dwordx4 v28, s[28:31], s62 offen offset:0 nt lds
    s_waitcnt vmcnt(25)
    s_lshl1_add_u32 s52, s50, -1
    v_mov_b32 v37, s52
    ds_write_b32 v36, v37 offset:16
    buffer_load_dwordx4 v29, s[28:31], s62 offen offset:1056 nt lds
    s_waitcnt vmcnt(25)
    buffer_load_dwordx4 v30, s[28:31], s62 offen offset:2112 nt lds
    s_waitcnt vmcnt(25)
    ds_read_b128 v[32:35], v36
    buffer_load_dwordx4 v31, s[28:31], s62 offen offset:3168 nt lds
    s_add_u32 m0, s54, 12672
    s_waitcnt vmcnt(25)
    buffer_load_dwordx4 v28, s[28:31], s63 offen offset:0 nt lds
    s_waitcnt vmcnt(25)
    buffer_load_dwordx4 v29, s[28:31], s63 offen offset:1056 nt lds
    s_waitcnt vmcnt(25)
    buffer_load_dwordx4 v30, s[28:31], s63 offen offset:2112 nt lds
    s_waitcnt vmcnt(25)
    buffer_load_dwordx4 v31, s[28:31], s63 offen offset:3168 nt lds
    s_add_u32 s50, s50, 1
    s_mov_b64 s[60:61], s[56:57]
    s_mov_b64 s[62:63], s[58:59]
    s_cmp_eq_u32 s50, 2
    s_cbranch_scc0 L_tab26
L_tw26:
    ds_read_b128 v[40:43], v36 offset:32
    ds_read_b128 v[20:23], v39
    s_waitcnt lgkmcnt(0)
    v_min3_u32 v40, v40, v41, v42
    v_min_u32 v40, v40, v43
    s_nop 0
    v_readfirstlane_b32 s47, v40
    s_nop 0
    s_cmp_eq_u32 s47, 0
    s_cbranch_scc1 L_tw26
L_tab26:
    v_readlane_b32 s56, v20, s50
    v_readlane_b32 s57, v21, s50
    v_readlane_b32 s58, v22, s50
    v_readlane_b32 s59, v23, s50
    s_add_u32 s53, s53, 17408
    s_cmp_ge_u32 s53, 69632
    s_cselect_b32 s53, 0, s53
    s_add_u32 s54, s54, 16896
    s_cmp_ge_u32 s54, 137216
    s_cselect_b32 s54, 69632, s54
    s_cmp_lt_u32 s50, s51
    s_cbranch_scc1 L_loop26
L_tail26:
    s_sub_i32 s48, s50, 3
    s_branch L_fchkb26
L_fspinb26:
    ds_read_b128 v[32:35], v36
L_fchkb26:
    s_waitcnt lgkmcnt(0)
    v_min_u32 v32, v32, v33
    v_min3_u32 v32, v32, v34, v35
    s_nop 0
    v_readfirstlane_b32 s47, v32
    s_nop 0
    s_cmp_ge_i32 s47, s48
    s_cbranch_scc0 L_fspinb26
    s_add_u32 m0, s54, 0
    s_waitcnt vmcnt(25)
    buffer_load_dwordx4 v28, s[28:31], s60 offen offset:0 nt lds
    s_waitcnt vmcnt(25)
    buffer_load_dwordx4 v29, s[28:31], s60 offen offset:1056 nt lds
    s_waitcnt vmcnt(25)
    buffer_load_dwordx4 v30, s[28:31], s60 offen offset:2112 nt lds
    s_waitcnt vmcnt(25)
    buffer_load_dwordx4 v31, s[28:31], s60 offen offset:3168 nt lds
    s_add_u32 m0, s54, 4224
    s_waitcnt vmcnt(25)
    buffer_load_dwordx4 v28, s[28:31], s61 offen offset:0 nt lds
    s_waitcnt vmcnt(25)
    buffer_load_dwordx4 v29, s[28:31], s61 offen offset:1056 nt lds
    s_waitcnt vmcnt(25)
    buffer_load_dwordx4 v30, s[28:31], s61 offen offset:2112 nt lds
    s_waitcnt vmcnt(25)
    buffer_load_dwordx4 v31, s[28:31], s61 offen offset:3168 nt lds
    s_add_u32 m0, s54, 8448
    s_waitcnt vmcnt(25)
    buffer_load_dwordx4 v28, s[28:31], s62 offen offset:0 nt lds
    s_waitcnt vmcnt(25)
    s_cmp_ge_u32 s50, 2
    s_cbranch_scc0 L_nbkb26
    s_lshl1_add_u32 s52, s50, -2
    v_mov_b32 v37, s52
    ds_write_b32 v36, v37 offset:16
L_nbkb26:
    buffer_load_dwordx4 v29, s[28:31], s62 offen offset:1056 nt lds
    s_waitcnt vmcnt(25)
    buffer_load_dwordx4 v30, s[28:31], s62 offen offset:2112 nt lds
    s_waitcnt vmcnt(25)
    buffer_load_dwordx4 v31, s[28:31], s62 offen offset:3168 nt lds
    s_add_u32 m0, s54, 12672
    s_waitcnt vmcnt(25)
    buffer_load_dwordx4 v28, s[28:31], s63 offen offset:0 nt lds
    s_waitcnt vmcnt(25)
    buffer_load_dwordx4 v29, s[28:31], s63 offen offset:1056 nt lds
    s_waitcnt vmcnt(25)
    buffer_load_dwordx4 v30, s[28:31], s63 offen offset:2112 nt lds
    s_waitcnt vmcnt(25)
    buffer_load_dwordx4 v31, s[28:31], s63 offen offset:3168 nt lds
    s_branch L_drain
L_pro27:
    s_mov_b32 m0, 8704
    s_nop 0
    buffer_load_dwordx4 v24, s[24:27], s62 offen offset:0 nt lds
    buffer_load_dwordx4 v25, s[24:27], s62 offen offset:1088 nt lds
    buffer_load_dwordx4 v26, s[24:27], s62 offen offset:2176 nt lds
    buffer_load_dwordx4 v27, s[24:27], s62 offen offset:3264 nt lds
    s_mov_b32 m0, 13056
    s_nop 0
    buffer_load_dwordx4 v24, s[24:27], s63 offen offset:0 nt lds
    buffer_load_dwordx4 v25, s[24:27], s63 offen offset:1088 nt lds
    buffer_load_dwordx4 v26, s[24:27], s63 offen offset:2176 nt lds
    buffer_load_dwordx4 v27, s[24:27], s63 offen offset:3264 nt lds
    s_mov_b32 s53, 17408
    s_cmp_ge_u32 s50, s51
    s_cbranch_scc1 L_tail27
    s_mov_b32 m0, 17408
    s_nop 0
    buffer_load_dwordx4 v24, s[24:27], s56 offen offset:0 nt lds
    buffer_load_dwordx4 v25, s[24:27], s56 offen offset:1088 nt lds
    buffer_load_dwordx4 v26, s[24:27], s56 offen offset:2176 nt lds
    buffer_load_dwordx4 v27, s[24:27], s56 offen offset:3264 nt lds
    s_mov_b32 m0, 21760
    s_nop 0
    buffer_load_dwordx4 v24, s[24:27], s57 offen offset:0 nt lds
    buffer_load_dwordx4 v25, s[24:27], s57 offen offset:1088 nt lds
    buffer_load_dwordx4 v26, s[24:27], s57 offen offset:2176 nt lds
    buffer_load_dwordx4 v27, s[24:27], s57 offen offset:3264 nt lds
    s_branch L_mid27
L_loop27:
    s_sub_i32 s48, s50, 3
    s_branch L_fchka27
L_fspina27:
    ds_read_b128 v[32:35], v36
L_fchka27:
    s_waitcnt lgkmcnt(0)
    v_min_u32 v32, v32, v33
    v_min3_u32 v32, v32, v34, v35
    s_nop 0
    v_readfirstlane_b32 s47, v32
    s_nop 0
    s_cmp_ge_i32 s47, s48
    s_cbranch_scc0 L_fspina27
    s_add_u32 m0, s53, 0
    s_waitcnt vmcnt(26)
    buffer_load_dwordx4 v24, s[24:27], s56 offen offset:0 nt lds
    s_waitcnt vmcnt(26)
    buffer_load_dwordx4 v25, s[24:27], s56 offen offset:1088 nt lds
    s_waitcnt vmcnt(26)
    buffer_load_dwordx4 v26, s[24:27], s56 offen offset:2176 nt lds
    s_waitcnt vmcnt(26)
    buffer_load_dwordx4 v27, s[24:27], s56 offen offset:3264 nt lds
    s_add_u32 m0, s53, 4352
    s_waitcnt vmcnt(26)
    buffer_load_dwordx4 v24, s[24:27], s57 offen offset:0 nt lds
    s_waitcnt vmcnt(26)
    buffer_load_dwordx4 v25, s[24:27], s57 offen offset:1088 nt lds
    s_waitcnt vmcnt(26)
    buffer_load_dwordx4 v26, s[24:27], s57 offen offset:2176 nt lds
    s_waitcnt vmcnt(26)
    buffer_load_dwordx4 v27, s[24:27], s57 offen offset:3264 nt lds
L_mid27:
    s_add_u32 m0, s53, 8704
    s_waitcnt vmcnt(26)
    buffer_load_dwordx4 v24, s[24:27], s58 offen offset:0 nt lds
    s_waitcnt vmcnt(26)
    buffer_load_dwordx4 v25, s[24:27], s58 offen offset:1088 nt lds
    s_waitcnt vmcnt(26)
    s_cmp_ge_u32 s50, 2
    s_cbranch_scc0 L_nbka27
    s_lshl1_add_u32 s52, s50, -2
    v_mov_b32 v37, s52
    ds_write_b32 v36, v37 offset:16
L_nbka27:
    buffer_load_dwordx4 v26, s[24:27], s58 offen offset:2176 nt lds
    s_waitcnt vmcnt(26)
    buffer_load_dwordx4 v27, s[24:27], s58 offen offset:3264 nt lds
    s_add_u32 m0, s53, 13056
    s_waitcnt vmcnt(26)
    buffer_load_dwordx4 v24, s[24:27], s59 offen offset:0 nt lds
    s_waitcnt vmcnt(26)
    buffer_load_dwordx4 v25, s[24:27], s59 offen offset:1088 nt lds
    s_waitcnt vmcnt(26)
    buffer_load_dwordx4 v26, s[24:27], s59 offen offset:2176 nt lds
    s_waitcnt vmcnt(26)
    buffer_load_dwordx4 v27, s[24:27], s59 offen offset:3264 nt lds
    s_add_u32 m0, s54, 0
    s_waitcnt vmcnt(26)
    buffer_load_dwordx4 v28, s[28:31], s60 offen offset:0 nt lds
    s_waitcnt vmcnt(26)
    buffer_load_dwordx4 v29, s[28:31], s60 offen offset:1056 nt lds
    s_waitcnt vmcnt(26)
    buffer_load_dwordx4 v30, s[28:31], s60 offen offset:2112 nt lds
    s_waitcnt vmcnt(26)
    buffer_load_dwordx4 v31, s[28:31], s60 offen offset:3168 nt lds
    s_add_u32 m0, s54, 4224
    s_waitcnt vmcnt(26)
    buffer_load_dwordx4 v28, s[28:31], s61 offen offset:0 nt lds
    s_waitcnt vmcnt(26)
    buffer_load_dwordx4 v29, s[28:31], s61 offen offset:1056 nt lds
    s_waitcnt vmcnt(26)
    buffer_load_dwordx4 v30, s[28:31], s61 offen offset:2112 nt lds
    s_waitcnt vmcnt(26)
    buffer_load_dwordx4 v31, s[28:31], s61 offen offset:3168 nt lds
    s_add_u32 m0, s54, 8448
    s_waitcnt vmcnt(26)
    buffer_load_dwordx4 v28, s[28:31], s62 offen offset:0 nt lds
    s_waitcnt vmcnt(26)
    buffer_load_dwordx4 v29, s[28:31], s62 offen offset:1056 nt lds
    s_waitcnt vmcnt(26)
    s_lshl1_add_u32 s52, s50, -1
    v_mov_b32 v37, s52
    ds_write_b32 v36, v37 offset:16
    buffer_load_dwordx4 v30, s[28:31], s62 offen offset:2112 nt lds
    s_waitcnt vmcnt(26)
    ds_read_b128 v[32:35], v36
    buffer_load_dwordx4 v31, s[28:31], s62 offen offset:3168 nt lds
    s_add_u32 m0, s54, 12672
    s_waitcnt vmcnt(26)
    buffer_load_dwordx4 v28, s[28:31], s63 offen offset:0 nt lds
    s_waitcnt vmcnt(26)
    buffer_load_dwordx4 v29, s[28:31], s63 offen offset:1056 nt lds
    s_waitcnt vmcnt(26)
    buffer_load_dwordx4 v30, s[28:31], s63 offen offset:2112 nt lds
    s_waitcnt vmcnt(26)
    buffer_load_dwordx4 v31, s[28:31], s63 offen offset:3168 nt lds
    s_add_u32 s50, s50, 1
    s_mov_b64 s[60:61], s[56:57]
    s_mov_b64 s[62:63], s[58:59]
    s_cmp_eq_u32 s50, 2
    s_cbranch_scc0 L_tab27
L_tw27:
    ds_read_b128 v[40:43], v36 offset:32
    ds_read_b128 v[20:23], v39
    s_waitcnt lgkmcnt(0)
    v_min3_u32 v40, v40, v41, v42
    v_min_u32 v40, v40, v43
    s_nop 0
    v_readfirstlane_b32 s47, v40
    s_nop 0
    s_cmp_eq_u32 s47, 0
    s_cbranch_scc1 L_tw27
L_tab27:
    v_readlane_b32 s56, v20, s50
    v_readlane_b32 s57, v21, s50
    v_readlane_b32 s58, v22, s50
    v_readlane_b32 s59, v23, s50
    s_add_u32 s53, s53, 17408
    s_cmp_ge_u32 s53, 69632
    s_cselect_b32 s53, 0, s53
    s_add_u32 s54, s54, 16896
    s_cmp_ge_u32 s54, 137216
    s_cselect_b32 s54, 69632, s54
    s_cmp_lt_u32 s50, s51
    s_cbranch_scc1 L_loop27
L_tail27:
    s_sub_i32 s48, s50, 3
    s_branch L_fchkb27
L_fspinb27:
    ds_read_b128 v[32:35], v36
L_fchkb27:
    s_waitcnt lgkmcnt(0)
    v_min_u32 v32, v32, v33
    v_min3_u32 v32, v32, v34, v35
    s_nop 0
    v_readfirstlane_b32 s47, v32
    s_nop 0
    s_cmp_ge_i32 s47, s48
    s_cbranch_scc0 L_fspinb27
    s_add_u32 m0, s54, 0
    s_waitcnt vmcnt(26)
    buffer_load_dwordx4 v28, s[28:31], s60 offen offset:0 nt lds
    s_waitcnt vmcnt(26)
    buffer_load_dwordx4 v29, s[28:31], s60 offen offset:1056 nt lds
    s_waitcnt vmcnt(26)
    buffer_load_dwordx4 v30, s[28:31], s60 offen offset:2112 nt lds
    s_waitcnt vmcnt(26)
    buffer_load_dwordx4 v31, s[28:31], s60 offen offset:3168 nt lds
    s_add_u32 m0, s54, 4224
    s_waitcnt vmcnt(26)
    buffer_load_dwordx4 v28, s[28:31], s61 offen offset:0 nt lds
    s_waitcnt vmcnt(26)
    buffer_load_dwordx4 v29, s[28:31], s61 offen offset:1056 nt lds
    s_waitcnt vmcnt(26)
    buffer_load_dwordx4 v30, s[28:31], s61 offen offset:2112 nt lds
    s_waitcnt vmcnt(26)
    buffer_load_dwordx4 v31, s[28:31], s61 offen offset:3168 nt lds
    s_add_u32 m0, s54, 8448
    s_waitcnt vmcnt(26)
    buffer_load_dwordx4 v28, s[28:31], s62 offen offset:0 nt lds
    s_waitcnt vmcnt(26)
    buffer_load_dwordx4 v29, s[28:31], s62 offen offset:1056 nt lds
    s_waitcnt vmcnt(26)
    s_cmp_ge_u32 s50, 2
    s_cbranch_scc0 L_nbkb27
    s_lshl1_add_u32 s52, s50, -2
    v_mov_b32 v37, s52
    ds_write_b32 v36, v37 offset:16
L_nbkb27:
    buffer_load_dwordx4 v30, s[28:31], s62 offen offset:2112 nt lds
    s_waitcnt vmcnt(26)
    buffer_load_dwordx4 v31, s[28:31], s62 offen offset:3168 nt lds
    s_add_u32 m0, s54, 12672
    s_waitcnt vmcnt(26)
    buffer_load_dwordx4 v28, s[28:31], s63 offen offset:0 nt lds
    s_waitcnt vmcnt(26)
    buffer_load_dwordx4 v29, s[28:31], s63 offen offset:1056 nt lds
    s_waitcnt vmcnt(26)
    buffer_load_dwordx4 v30, s[28:31], s63 offen offset:2112 nt lds
    s_waitcnt vmcnt(26)
    buffer_load_dwordx4 v31, s[28:31], s63 offen offset:3168 nt lds
    s_branch L_drain
L_pro28:
    s_mov_b32 m0, 8704
    s_nop 0
    buffer_load_dwordx4 v24, s[24:27], s62 offen offset:0 nt lds
    buffer_load_dwordx4 v25, s[24:27], s62 offen offset:1088 nt lds
    buffer_load_dwordx4 v26, s[24:27], s62 offen offset:2176 nt lds
    buffer_load_dwordx4 v27, s[24:27], s62 offen offset:3264 nt lds
    s_mov_b32 m0, 13056
    s_nop 0
    buffer_load_dwordx4 v24, s[24:27], s63 offen offset:0 nt lds
    buffer_load_dwordx4 v25, s[24:27], s63 offen offset:1088 nt lds
    buffer_load_dwordx4 v26, s[24:27], s63 offen offset:2176 nt lds
    buffer_load_dwordx4 v27, s[24:27], s63 offen offset:3264 nt lds
    s_mov_b32 s53, 17408
    s_cmp_ge_u32 s50, s51
    s_cbranch_scc1 L_tail28
    s_mov_b32 m0, 17408
    s_nop 0
    buffer_load_dwordx4 v24, s[24:27], s56 offen offset:0 nt lds
    buffer_load_dwordx4 v25, s[24:27], s56 offen offset:1088 nt lds
    buffer_load_dwordx4 v26, s[24:27], s56 offen offset:2176 nt lds
    buffer_load_dwordx4 v27, s[24:27], s56 offen offset:3264 nt lds
    s_mov_b32 m0, 21760
    s_nop 0
    buffer_load_dwordx4 v24, s[24:27], s57 offen offset:0 nt lds
    buffer_load_dwordx4 v25, s[24:27], s57 offen offset:1088 nt lds
    buffer_load_dwordx4 v26, s[24:27], s57 offen offset:2176 nt lds
    buffer_load_dwordx4 v27, s[24:27], s57 offen offset:3264 nt lds
    s_mov_b32 m0, 26112
    s_nop 0
    buffer_load_dwordx4 v24, s[24:27], s58 offen offset:0 nt lds
    buffer_load_dwordx4 v25, s[24:27], s58 offen offset:1088 nt lds
    buffer_load_dwordx4 v26, s[24:27], s58 offen offset:2176 nt lds
    buffer_load_dwordx4 v27, s[24:27], s58 offen offset:3264 nt lds
    s_branch L_mid28
L_loop28:
    s_sub_i32 s48, s50, 3
    s_branch L_fchka28
L_fspina28:
    ds_read_b128 v[32:35], v36
L_fchka28:
    s_waitcnt lgkmcnt(0)
    v_min_u32 v32, v32, v33
    v_min3_u32 v32, v32, v34, v35
    s_nop 0
    v_readfirstlane_b32 s47, v32
    s_nop 0
    s_cmp_ge_i32 s47, s48
    s_cbranch_scc0 L_fspina28
    s_add_u32 m0, s53, 0
    s_waitcnt vmcnt(27)
    buffer_load_dwordx4 v24, s[24:27], s56 offen offset:0 nt lds
    s_waitcnt vmcnt(27)
    buffer_load_dwordx4 v25, s[24:27], s56 offen offset:1088 nt lds
    s_waitcnt vmcnt(27)
    buffer_load_dwordx4 v26, s[24:27], s56 offen offset:2176 nt lds
    s_waitcnt vmcnt(27)
    buffer_load_dwordx4 v27, s[24:27], s56 offen offset:3264 nt lds
    s_add_u32 m0, s53, 4352
    s_waitcnt vmcnt(27)
    buffer_load_dwordx4 v24, s[24:27], s57 offen offset:0 nt lds
    s_waitcnt vmcnt(27)
    buffer_load_dwordx4 v25, s[24:27], s57 offen offset:1088 nt lds
    s_waitcnt vmcnt(27)
    buffer_load_dwordx4 v26, s[24:27], s57 offen offset:2176 nt lds
    s_waitcnt vmcnt(27)
    buffer_load_dwordx4 v27, s[24:27], s57 offen offset:3264 nt lds
    s_add_u32 m0, s53, 8704
    s_waitcnt vmcnt(27)
    buffer_load_dwordx4 v24, s[24:27], s58 offen offset:0 nt lds
    s_waitcnt vmcnt(27)
    buffer_load_dwordx4 v25, s[24:27], s58 offen offset:1088 nt lds
    s_waitcnt vmcnt(27)
    buffer_load_dwordx4 v26, s[24:27], s58 offen offset:2176 nt lds
    s_waitcnt vmcnt(27)
    s_cmp_ge_u32 s50, 2
    s_cbranch_scc0 L_nbka28
    s_lshl1_add_u32 s52, s50, -2
    v_mov_b32 v37, s52
    ds_write_b32 v36, v37 offset:16
L_nbka28:
    buffer_load_dwordx4 v27, s[24:27], s58 offen offset:3264 nt lds
L_mid28:
    s_add_u32 m0, s53, 13056
    s_waitcnt vmcnt(27)
    buffer_load_dwordx4 v24, s[24:27], s59 offen offset:0 nt lds
    s_waitcnt vmcnt(27)
    buffer_load_dwordx4 v25, s[24:27], s59 offen offset:1088 nt lds
    s_waitcnt vmcnt(27)
    buffer_load_dwordx4 v26, s[24:27], s59 offen offset:2176 nt lds
    s_waitcnt vmcnt(27)
    buffer_load_dwordx4 v27, s[24:27], s59 offen offset:3264 nt lds
    s_add_u32 m0, s54, 0
    s_waitcnt vmcnt(27)
    buffer_load_dwordx4 v28, s[28:31], s60 offen offset:0 nt lds
    s_waitcnt vmcnt(27)
    buffer_load_dwordx4 v29, s[28:31], s60 offen offset:1056 nt lds
    s_waitcnt vmcnt(27)
    buffer_load_dwordx4 v30, s[28:31], s60 offen offset:2112 nt lds
    s_waitcnt vmcnt(27)
    buffer_load_dwordx4 v31, s[28:31], s60 offen offset:3168 nt lds
    s_add_u32 m0, s54, 4224
    s_waitcnt vmcnt(27)
    buffer_load_dwordx4 v28, s[28:31], s61 offen offset:0 nt lds
    s_waitcnt vmcnt(27)
    buffer_load_dwordx4 v29, s[28:31], s61 offen offset:1056 nt lds
    s_waitcnt vmcnt(27)
    buffer_load_dwordx4 v30, s[28:31], s61 offen offset:2112 nt lds
    s_waitcnt vmcnt(27)
    buffer_load_dwordx4 v31, s[28:31], s61 offen offset:3168 nt lds
    s_add_u32 m0, s54, 8448
    s_waitcnt vmcnt(27)
    buffer_load_dwordx4 v28, s[28:31], s62 offen offset:0 nt lds
    s_waitcnt vmcnt(27)
    buffer_load_dwordx4 v29, s[28:31], s62 offen offset:1056 nt lds
    s_waitcnt vmcnt(27)
    buffer_load_dwordx4 v30, s[28:31], s62 offen offset:2112 nt lds
    s_waitcnt vmcnt(27)
    s_lshl1_add_u32 s52, s50, -1
    v_mov_b32 v37, s52
    ds_write_b32 v36, v37 offset:16
    ds_read_b128 v[32:35], v36
    buffer_load_dwordx4 v31, s[28:31], s62 offen offset:3168 nt lds
    s_add_u32 m0, s54, 12672
    s_waitcnt vmcnt(27)
    buffer_load_dwordx4 v28, s[28:31], s63 offen offset:0 nt lds
    s_waitcnt vmcnt(27)
    buffer_load_dwordx4 v29, s[28:31], s63 offen offset:1056 nt lds
    s_waitcnt vmcnt(27)
    buffer_load_dwordx4 v30, s[28:31], s63 offen offset:2112 nt lds
    s_waitcnt vmcnt(27)
    buffer_load_dwordx4 v31, s[28:31], s63 offen offset:3168 nt lds
    s_add_u32 s50, s50, 1
    s_mov_b64 s[60:61], s[56:57]
    s_mov_b64 s[62:63], s[58:59]
    s_cmp_eq_u32 s50, 2
    s_cbranch_scc0 L_tab28
L_tw28:
    ds_read_b128 v[40:43], v36 offset:32
    ds_read_b128 v[20:23], v39
    s_waitcnt lgkmcnt(0)
    v_min3_u32 v40, v40, v41, v42
    v_min_u32 v40, v40, v43
    s_nop 0
    v_readfirstlane_b32 s47, v40
    s_nop 0
    s_cmp_eq_u32 s47, 0
    s_cbranch_scc1 L_tw28
L_tab28:
    v_readlane_b32 s56, v20, s50
    v_readlane_b32 s57, v21, s50
    v_readlane_b32 s58, v22, s50
    v_readlane_b32 s59, v23, s50
    s_add_u32 s53, s53, 17408
    s_cmp_ge_u32 s53, 69632
    s_cselect_b32 s53, 0, s53
    s_add_u32 s54, s54, 16896
    s_cmp_ge_u32 s54, 137216
    s_cselect_b32 s54, 69632, s54
    s_cmp_lt_u32 s50, s51
    s_cbranch_scc1 L_loop28
L_tail28:
    s_sub_i32 s48, s50, 3
    s_branch L_fchkb28
L_fspinb28:
    ds_read_b128 v[32:35], v36
L_fchkb28:
    s_waitcnt lgkmcnt(0)
    v_min_u32 v32, v32, v33
    v_min3_u32 v32, v32, v34, v35
    s_nop 0
    v_readfirstlane_b32 s47, v32
    s_nop 0
    s_cmp_ge_i32 s47, s48
    s_cbranch_scc0 L_fspinb28
    s_add_u32 m0, s54, 0
    s_waitcnt vmcnt(27)
    buffer_load_dwordx4 v28, s[28:31], s60 offen offset:0 nt lds
    s_waitcnt vmcnt(27)
    buffer_load_dwordx4 v29, s[28:31], s60 offen offset:1056 nt lds
    s_waitcnt vmcnt(27)
    buffer_load_dwordx4 v30, s[28:31], s60 offen offset:2112 nt lds
    s_waitcnt vmcnt(27)
    buffer_load_dwordx4 v31, s[28:31], s60 offen offset:3168 nt lds
    s_add_u32 m0, s54, 4224
    s_waitcnt vmcnt(27)
    buffer_load_dwordx4 v28, s[28:31], s61 offen offset:0 nt lds
    s_waitcnt vmcnt(27)
    buffer_load_dwordx4 v29, s[28:31], s61 offen offset:1056 nt lds
    s_waitcnt vmcnt(27)
    buffer_load_dwordx4 v30, s[28:31], s61 offen offset:2112 nt lds
    s_waitcnt vmcnt(27)
    buffer_load_dwordx4 v31, s[28:31], s61 offen offset:3168 nt lds
    s_add_u32 m0, s54, 8448
    s_waitcnt vmcnt(27)
    buffer_load_dwordx4 v28, s[28:31], s62 offen offset:0 nt lds
    s_waitcnt vmcnt(27)
    buffer_load_dwordx4 v29, s[28:31], s62 offen offset:1056 nt lds
    s_waitcnt vmcnt(27)
    buffer_load_dwordx4 v30, s[28:31], s62 offen offset:2112 nt lds
    s_waitcnt vmcnt(27)
    s_cmp_ge_u32 s50, 2
    s_cbranch_scc0 L_nbkb28
    s_lshl1_add_u32 s52, s50, -2
    v_mov_b32 v37, s52
    ds_write_b32 v36, v37 offset:16
L_nbkb28:
    buffer_load_dwordx4 v31, s[28:31], s62 offen offset:3168 nt lds
    s_add_u32 m0, s54, 12672
    s_waitcnt vmcnt(27)
    buffer_load_dwordx4 v28, s[28:31], s63 offen offset:0 nt lds
    s_waitcnt vmcnt(27)
    buffer_load_dwordx4 v29, s[28:31], s63 offen offset:1056 nt lds
    s_waitcnt vmcnt(27)
    buffer_load_dwordx4 v30, s[28:31], s63 offen offset:2112 nt lds
    s_waitcnt vmcnt(27)
    buffer_load_dwordx4 v31, s[28:31], s63 offen offset:3168 nt lds
    s_branch L_drain
L_pro29:
    s_mov_b32 m0, 8704
    s_nop 0
    buffer_load_dwordx4 v24, s[24:27], s62 offen offset:0 nt lds
    buffer_load_dwordx4 v25, s[24:27], s62 offen offset:1088 nt lds
    buffer_load_dwordx4 v26, s[24:27], s62 offen offset:2176 nt lds
    buffer_load_dwordx4 v27, s[24:27], s62 offen offset:3264 nt lds
    s_mov_b32 m0, 13056
    s_nop 0
    buffer_load_dwordx4 v24, s[24:27], s63 offen offset:0 nt lds
    buffer_load_dwordx4 v25, s[24:27], s63 offen offset:1088 nt lds
    buffer_load_dwordx4 v26, s[24:27], s63 offen offset:2176 nt lds
    buffer_load_dwordx4 v27, s[24:27], s63 offen offset:3264 nt lds
    s_mov_b32 s53, 17408
    s_cmp_ge_u32 s50, s51
    s_cbranch_scc1 L_tail29
    s_mov_b32 m0, 17408
    s_nop 0
    buffer_load_dwordx4 v24, s[24:27], s56 offen offset:0 nt lds
    buffer_load_dwordx4 v25, s[24:27], s56 offen offset:1088 nt lds
    buffer_load_dwordx4 v26, s[24:27], s56 offen offset:2176 nt lds
    buffer_load_dwordx4 v27, s[24:27], s56 offen offset:3264 nt lds
    s_mov_b32 m0, 21760
    s_nop 0
    buffer_load_dwordx4 v24, s[24:27], s57 offen offset:0 nt lds
    buffer_load_dwordx4 v25, s[24:27], s57 offen offset:1088 nt lds
    buffer_load_dwordx4 v26, s[24:27], s57 offen offset:2176 nt lds
    buffer_load_dwordx4 v27, s[24:27], s57 offen offset:3264 nt lds
    s_mov_b32 m0, 26112
    s_nop 0
    buffer_load_dwordx4 v24, s[24:27], s58 offen offset:0 nt lds
    buffer_load_dwordx4 v25, s[24:27], s58 offen offset:1088 nt lds
    buffer_load_dwordx4 v26, s[24:27], s58 offen offset:2176 nt lds
    buffer_load_dwordx4 v27, s[24:27], s58 offen offset:3264 nt lds
    s_branch L_mid29
L_loop29:
    s_sub_i32 s48, s50, 3
    s_branch L_fchka29
L_fspina29:
    ds_read_b128 v[32:35], v36
L_fchka29:
    s_waitcnt lgkmcnt(0)
    v_min_u32 v32, v32, v33
    v_min3_u32 v32, v32, v34, v35
    s_nop 0
    v_readfirstlane_b32 s47, v32
    s_nop 0
    s_cmp_ge_i32 s47, s48
    s_cbranch_scc0 L_fspina29
    s_add_u32 m0, s53, 0
    s_waitcnt vmcnt(28)
    buffer_load_dwordx4 v24, s[24:27], s56 offen offset:0 nt lds
    s_waitcnt vmcnt(28)
    buffer_load_dwordx4 v25, s[24:27], s56 offen offset:1088 nt lds
    s_waitcnt vmcnt(28)
    buffer_load_dwordx4 v26, s[24:27], s56 offen offset:2176 nt lds
    s_waitcnt vmcnt(28)
    buffer_load_dwordx4 v27, s[24:27], s56 offen offset:3264 nt lds
    s_add_u32 m0, s53, 4352
    s_waitcnt vmcnt(28)
    buffer_load_dwordx4 v24, s[24:27], s57 offen offset:0 nt lds
    s_waitcnt vmcnt(28)
    buffer_load_dwordx4 v25, s[24:27], s57 offen offset:1088 nt lds
    s_waitcnt vmcnt(28)
    buffer_load_dwordx4 v26, s[24:27], s57 offen offset:2176 nt lds
    s_waitcnt vmcnt(28)
    buffer_load_dwordx4 v27, s[24:27], s57 offen offset:3264 nt lds
    s_add_u32 m0, s53, 8704
    s_waitcnt vmcnt(28)
    buffer_load_dwordx4 v24, s[24:27], s58 offen offset:0 nt lds
    s_waitcnt vmcnt(28)
    buffer_load_dwordx4 v25, s[24:27], s58 offen offset:1088 nt lds
    s_waitcnt vmcnt(28)
    buffer_load_dwordx4 v26, s[24:27], s58 offen offset:2176 nt lds
    s_waitcnt vmcnt(28)
    buffer_load_dwordx4 v27, s[24:27], s58 offen offset:3264 nt lds
L_mid29:
    s_add_u32 m0, s53, 13056
    s_waitcnt vmcnt(28)
    s_cmp_ge_u32 s50, 2
    s_cbranch_scc0 L_nbka29
    s_lshl1_add_u32 s52, s50, -2
    v_mov_b32 v37, s52
    ds_write_b32 v36, v37 offset:16
L_nbka29:
    buffer_load_dwordx4 v24, s[24:27], s59 offen offset:0 nt lds
    s_waitcnt vmcnt(28)
    buffer_load_dwordx4 v25, s[24:27], s59 offen offset:1088 nt lds
    s_waitcnt vmcnt(28)
    buffer_load_dwordx4 v26, s[24:27], s59 offen offset:2176 nt lds
    s_waitcnt vmcnt(28)
    buffer_load_dwordx4 v27, s[24:27], s59 offen offset:3264 nt lds
    s_add_u32 m0, s54, 0
    s_waitcnt vmcnt(28)
    buffer_load_dwordx4 v28, s[28:31], s60 offen offset:0 nt lds
    s_waitcnt vmcnt(28)
    buffer_load_dwordx4 v29, s[28:31], s60 offen offset:1056 nt lds
    s_waitcnt vmcnt(28)
    buffer_load_dwordx4 v30, s[28:31], s60 offen offset:2112 nt lds
    s_waitcnt vmcnt(28)
    buffer_load_dwordx4 v31, s[28:31], s60 offen offset:3168 nt lds
    s_add_u32 m0, s54, 4224
    s_waitcnt vmcnt(28)
    buffer_load_dwordx4 v28, s[28:31], s61 offen offset:0 nt lds
    s_waitcnt vmcnt(28)
    buffer_load_dwordx4 v29, s[28:31], s61 offen offset:1056 nt lds
    s_waitcnt vmcnt(28)
    buffer_load_dwordx4 v30, s[28:31], s61 offen offset:2112 nt lds
    s_waitcnt vmcnt(28)
    buffer_load_dwordx4 v31, s[28:31], s61 offen offset:3168 nt lds
    s_add_u32 m0, s54, 8448
    s_waitcnt vmcnt(28)
    buffer_load_dwordx4 v28, s[28:31], s62 offen offset:0 nt lds
    s_waitcnt vmcnt(28)
    buffer_load_dwordx4 v29, s[28:31], s62 offen offset:1056 nt lds
    s_waitcnt vmcnt(28)
    buffer_load_dwordx4 v30, s[28:31], s62 offen offset:2112 nt lds
    s_waitcnt vmcnt(28)
    ds_read_b128 v[32:35], v36
    buffer_load_dwordx4 v31, s[28:31], s62 offen offset:3168 nt lds
    s_add_u32 m0, s54, 12672
    s_waitcnt vmcnt(28)
    s_lshl1_add_u32 s52, s50, -1
    v_mov_b32 v37, s52
    ds_write_b32 v36, v37 offset:16
    buffer_load_dwordx4 v28, s[28:31], s63 offen offset:0 nt lds
    s_waitcnt vmcnt(28)
    buffer_load_dwordx4 v29, s[28:31], s63 offen offset:1056 nt lds
    s_waitcnt vmcnt(28)
    buffer_load_dwordx4 v30, s[28:31], s63 offen offset:2112 nt lds
    s_waitcnt vmcnt(28)
    buffer_load_dwordx4 v31, s[28:31], s63 offen offset:3168 nt lds
    s_add_u32 s50, s50, 1
    s_mov_b64 s[60:61], s[56:57]
    s_mov_b64 s[62:63], s[58:59]
    s_cmp_eq_u32 s50, 2
    s_cbranch_scc0 L_tab29
L_tw29:
    ds_read_b128 v[40:43], v36 offset:32
    ds_read_b128 v[20:23], v39
    s_waitcnt lgkmcnt(0)
    v_min3_u32 v40, v40, v41, v42
    v_min_u32 v40, v40, v43
    s_nop 0
    v_readfirstlane_b32 s47, v40
    s_nop 0
    s_cmp_eq_u32 s47, 0
    s_cbranch_scc1 L_tw29
L_tab29:
    v_readlane_b32 s56, v20, s50
    v_readlane_b32 s57, v21, s50
    v_readlane_b32 s58, v22, s50
    v_readlane_b32 s59, v23, s50
    s_add_u32 s53, s53, 17408
    s_cmp_ge_u32 s53, 69632
    s_cselect_b32 s53, 0, s53
    s_add_u32 s54, s54, 16896
    s_cmp_ge_u32 s54, 137216
    s_cselect_b32 s54, 69632, s54
    s_cmp_lt_u32 s50, s51
    s_cbranch_scc1 L_loop29
L_tail29:
    s_sub_i32 s48, s50, 3
    s_branch L_fchkb29
L_fspinb29:
    ds_read_b128 v[32:35], v36
L_fchkb29:
    s_waitcnt lgkmcnt(0)
    v_min_u32 v32, v32, v33
    v_min3_u32 v32, v32, v34, v35
    s_nop 0
    v_readfirstlane_b32 s47, v32
    s_nop 0
    s_cmp_ge_i32 s47, s48
    s_cbranch_scc0 L_fspinb29
    s_add_u32 m0, s54, 0
    s_waitcnt vmcnt(28)
    buffer_load_dwordx4 v28, s[28:31], s60 offen offset:0 nt lds
    s_waitcnt vmcnt(28)
    buffer_load_dwordx4 v29, s[28:31], s60 offen offset:1056 nt lds
    s_waitcnt vmcnt(28)
    buffer_load_dwordx4 v30, s[28:31], s60 offen offset:2112 nt lds
    s_waitcnt vmcnt(28)
    buffer_load_dwordx4 v31, s[28:31], s60 offen offset:3168 nt lds
    s_add_u32 m0, s54, 4224
    s_waitcnt vmcnt(28)
    buffer_load_dwordx4 v28, s[28:31], s61 offen offset:0 nt lds
    s_waitcnt vmcnt(28)
    buffer_load_dwordx4 v29, s[28:31], s61 offen offset:1056 nt lds
    s_waitcnt vmcnt(28)
    buffer_load_dwordx4 v30, s[28:31], s61 offen offset:2112 nt lds
    s_waitcnt vmcnt(28)
    buffer_load_dwordx4 v31, s[28:31], s61 offen offset:3168 nt lds
    s_add_u32 m0, s54, 8448
    s_waitcnt vmcnt(28)
    buffer_load_dwordx4 v28, s[28:31], s62 offen offset:0 nt lds
    s_waitcnt vmcnt(28)
    buffer_load_dwordx4 v29, s[28:31], s62 offen offset:1056 nt lds
    s_waitcnt vmcnt(28)
    buffer_load_dwordx4 v30, s[28:31], s62 offen offset:2112 nt lds
    s_waitcnt vmcnt(28)
    buffer_load_dwordx4 v31, s[28:31], s62 offen offset:3168 nt lds
    s_add_u32 m0, s54, 12672
    s_waitcnt vmcnt(28)
    s_cmp_ge_u32 s50, 2
    s_cbranch_scc0 L_nbkb29
    s_lshl1_add_u32 s52, s50, -2
    v_mov_b32 v37, s52
    ds_write_b32 v36, v37 offset:16
L_nbkb29:
    buffer_load_dwordx4 v28, s[28:31], s63 offen offset:0 nt lds
    s_waitcnt vmcnt(28)
    buffer_load_dwordx4 v29, s[28:31], s63 offen offset:1056 nt lds
    s_waitcnt vmcnt(28)
    buffer_load_dwordx4 v30, s[28:31], s63 offen offset:2112 nt lds
    s_waitcnt vmcnt(28)
    buffer_load_dwordx4 v31, s[28:31], s63 offen offset:3168 nt lds
    s_branch L_drain
L_pro30:
    s_mov_b32 m0, 8704
    s_nop 0
    buffer_load_dwordx4 v24, s[24:27], s62 offen offset:0 nt lds
    buffer_load_dwordx4 v25, s[24:27], s62 offen offset:1088 nt lds
    buffer_load_dwordx4 v26, s[24:27], s62 offen offset:2176 nt lds
    buffer_load_dwordx4 v27, s[24:27], s62 offen offset:3264 nt lds
    s_mov_b32 m0, 13056
    s_nop 0
    buffer_load_dwordx4 v24, s[24:27], s63 offen offset:0 nt lds
    buffer_load_dwordx4 v25, s[24:27], s63 offen offset:1088 nt lds
    buffer_load_dwordx4 v26, s[24:27], s63 offen offset:2176 nt lds
    buffer_load_dwordx4 v27, s[24:27], s63 offen offset:3264 nt lds
    s_mov_b32 s53, 17408
    s_cmp_ge_u32 s50, s51
    s_cbranch_scc1 L_tail30
    s_mov_b32 m0, 17408
    s_nop 0
    buffer_load_dwordx4 v24, s[24:27], s56 offen offset:0 nt lds
    buffer_load_dwordx4 v25, s[24:27], s56 offen offset:1088 nt lds
    buffer_load_dwordx4 v26, s[24:27], s56 offen offset:2176 nt lds
    buffer_load_dwordx4 v27, s[24:27], s56 offen offset:3264 nt lds
    s_mov_b32 m0, 21760
    s_nop 0
    buffer_load_dwordx4 v24, s[24:27], s57 offen offset:0 nt lds
    buffer_load_dwordx4 v25, s[24:27], s57 offen offset:1088 nt lds
    buffer_load_dwordx4 v26, s[24:27], s57 offen offset:2176 nt lds
    buffer_load_dwordx4 v27, s[24:27], s57 offen offset:3264 nt lds
    s_mov_b32 m0, 26112
    s_nop 0
    buffer_load_dwordx4 v24, s[24:27], s58 offen offset:0 nt lds
    buffer_load_dwordx4 v25, s[24:27], s58 offen offset:1088 nt lds
    buffer_load_dwordx4 v26, s[24:27], s58 offen offset:2176 nt lds
    buffer_load_dwordx4 v27, s[24:27], s58 offen offset:3264 nt lds
    s_branch L_mid30
L_loop30:
    s_sub_i32 s48, s50, 3
    s_branch L_fchka30
L_fspina30:
    ds_read_b128 v[32:35], v36
L_fchka30:
    s_waitcnt lgkmcnt(0)
    v_min_u32 v32, v32, v33
    v_min3_u32 v32, v32, v34, v35
    s_nop 0
    v_readfirstlane_b32 s47, v32
    s_nop 0
    s_cmp_ge_i32 s47, s48
    s_cbranch_scc0 L_fspina30
    s_add_u32 m0, s53, 0
    s_waitcnt vmcnt(29)
    buffer_load_dwordx4 v24, s[24:27], s56 offen offset:0 nt lds
    s_waitcnt vmcnt(29)
    buffer_load_dwordx4 v25, s[24:27], s56 offen offset:1088 nt lds
    s_waitcnt vmcnt(29)
    buffer_load_dwordx4 v26, s[24:27], s56 offen offset:2176 nt lds
    s_waitcnt vmcnt(29)
    buffer_load_dwordx4 v27, s[24:27], s56 offen offset:3264 nt lds
    s_add_u32 m0, s53, 4352
    s_waitcnt vmcnt(29)
    buffer_load_dwordx4 v24, s[24:27], s57 offen offset:0 nt lds
    s_waitcnt vmcnt(29)
    buffer_load_dwordx4 v25, s[24:27], s57 offen offset:1088 nt lds
    s_waitcnt vmcnt(29)
    buffer_load_dwordx4 v26, s[24:27], s57 offen offset:2176 nt lds
    s_waitcnt vmcnt(29)
    buffer_load_dwordx4 v27, s[24:27], s57 offen offset:3264 nt lds
    s_add_u32 m0, s53, 8704
    s_waitcnt vmcnt(29)
    buffer_load_dwordx4 v24, s[24:27], s58 offen offset:0 nt lds
    s_waitcnt vmcnt(29)
    buffer_load_dwordx4 v25, s[24:27], s58 offen offset:1088 nt lds
    s_waitcnt vmcnt(29)
    buffer_load_dwordx4 v26, s[24:27], s58 offen offset:2176 nt lds
    s_waitcnt vmcnt(29)
    buffer_load_dwordx4 v27, s[24:27], s58 offen offset:3264 nt lds
L_mid30:
    s_add_u32 m0, s53, 13056
    s_waitcnt vmcnt(29)
    buffer_load_dwordx4 v24, s[24:27], s59 offen offset:0 nt lds
    s_waitcnt vmcnt(29)
    s_cmp_ge_u32 s50, 2
    s_cbranch_scc0 L_nbka30
    s_lshl1_add_u32 s52, s50, -2
    v_mov_b32 v37, s52
    ds_write_b32 v36, v37 offset:16
L_nbka30:
    buffer_load_dwordx4 v25, s[24:27], s59 offen offset:1088 nt lds
    s_waitcnt vmcnt(29)
    buffer_load_dwordx4 v26, s[24:27], s59 offen offset:2176 nt lds
    s_waitcnt vmcnt(29)
    buffer_load_dwordx4 v27, s[24:27], s59 offen offset:3264 nt lds
    s_add_u32 m0, s54, 0
    s_waitcnt vmcnt(29)
    buffer_load_dwordx4 v28, s[28:31], s60 offen offset:0 nt lds
    s_waitcnt vmcnt(29)
    buffer_load_dwordx4 v29, s[28:31], s60 offen offset:1056 nt lds
    s_waitcnt vmcnt(29)
    buffer_load_dwordx4 v30, s[28:31], s60 offen offset:2112 nt lds
    s_waitcnt vmcnt(29)
    buffer_load_dwordx4 v31, s[28:31], s60 offen offset:3168 nt lds
    s_add_u32 m0, s54, 4224
    s_waitcnt vmcnt(29)
    buffer_load_dwordx4 v28, s[28:31], s61 offen offset:0 nt lds
    s_waitcnt vmcnt(29)
    buffer_load_dwordx4 v29, s[28:31], s61 offen offset:1056 nt lds
    s_waitcnt vmcnt(29)
    buffer_load_dwordx4 v30, s[28:31], s61 offen offset:2112 nt lds
    s_waitcnt vmcnt(29)
    buffer_load_dwordx4 v31, s[28:31], s61 offen offset:3168 nt lds
    s_add_u32 m0, s54, 8448
    s_waitcnt vmcnt(29)
    buffer_load_dwordx4 v28, s[28:31], s62 offen offset:0 nt lds
    s_waitcnt vmcnt(29)
    buffer_load_dwordx4 v29, s[28:31], s62 offen offset:1056 nt lds
    s_waitcnt vmcnt(29)
    buffer_load_dwordx4 v30, s[28:31], s62 offen offset:2112 nt lds
    s_waitcnt vmcnt(29)
    ds_read_b128 v[32:35], v36
    buffer_load_dwordx4 v31, s[28:31], s62 offen offset:3168 nt lds
    s_add_u32 m0, s54, 12672
    s_waitcnt vmcnt(29)
    buffer_load_dwordx4 v28, s[28:31], s63 offen offset:0 nt lds
    s_waitcnt vmcnt(29)
    s_lshl1_add_u32 s52, s50, -1
    v_mov_b32 v37, s52
    ds_write_b32 v36, v37 offset:16
    buffer_load_dwordx4 v29, s[28:31], s63 offen offset:1056 nt lds
    s_waitcnt vmcnt(29)
    buffer_load_dwordx4 v30, s[28:31], s63 offen offset:2112 nt lds
    s_waitcnt vmcnt(29)
    buffer_load_dwordx4 v31, s[28:31], s63 offen offset:3168 nt lds
    s_add_u32 s50, s50, 1
    s_mov_b64 s[60:61], s[56:57]
    s_mov_b64 s[62:63], s[58:59]
    s_cmp_eq_u32 s50, 2
    s_cbranch_scc0 L_tab30
L_tw30:
    ds_read_b128 v[40:43], v36 offset:32
    ds_read_b128 v[20:23], v39
    s_waitcnt lgkmcnt(0)
    v_min3_u32 v40, v40, v41, v42
    v_min_u32 v40, v40, v43
    s_nop 0
    v_readfirstlane_b32 s47, v40
    s_nop 0
    s_cmp_eq_u32 s47, 0
    s_cbranch_scc1 L_tw30
L_tab30:
    v_readlane_b32 s56, v20, s50
    v_readlane_b32 s57, v21, s50
    v_readlane_b32 s58, v22, s50
    v_readlane_b32 s59, v23, s50
    s_add_u32 s53, s53, 17408
    s_cmp_ge_u32 s53, 69632
    s_cselect_b32 s53, 0, s53
    s_add_u32 s54, s54, 16896
    s_cmp_ge_u32 s54, 137216
    s_cselect_b32 s54, 69632, s54
    s_cmp_lt_u32 s50, s51
    s_cbranch_scc1 L_loop30
L_tail30:
    s_sub_i32 s48, s50, 3
    s_branch L_fchkb30
L_fspinb30:
    ds_read_b128 v[32:35], v36
L_fchkb30:
    s_waitcnt lgkmcnt(0)
    v_min_u32 v32, v32, v33
    v_min3_u32 v32, v32, v34, v35
    s_nop 0
    v_readfirstlane_b32 s47, v32
    s_nop 0
    s_cmp_ge_i32 s47, s48
    s_cbranch_scc0 L_fspinb30
    s_add_u32 m0, s54, 0
    s_waitcnt vmcnt(29)
    buffer_load_dwordx4 v28, s[28:31], s60 offen offset:0 nt lds
    s_waitcnt vmcnt(29)
    buffer_load_dwordx4 v29, s[28:31], s60 offen offset:1056 nt lds
    s_waitcnt vmcnt(29)
    buffer_load_dwordx4 v30, s[28:31], s60 offen offset:2112 nt lds
    s_waitcnt vmcnt(29)
    buffer_load_dwordx4 v31, s[28:31], s60 offen offset:3168 nt lds
    s_add_u32 m0, s54, 4224
    s_waitcnt vmcnt(29)
    buffer_load_dwordx4 v28, s[28:31], s61 offen offset:0 nt lds
    s_waitcnt vmcnt(29)
    buffer_load_dwordx4 v29, s[28:31], s61 offen offset:1056 nt lds
    s_waitcnt vmcnt(29)
    buffer_load_dwordx4 v30, s[28:31], s61 offen offset:2112 nt lds
    s_waitcnt vmcnt(29)
    buffer_load_dwordx4 v31, s[28:31], s61 offen offset:3168 nt lds
    s_add_u32 m0, s54, 8448
    s_waitcnt vmcnt(29)
    buffer_load_dwordx4 v28, s[28:31], s62 offen offset:0 nt lds
    s_waitcnt vmcnt(29)
    buffer_load_dwordx4 v29, s[28:31], s62 offen offset:1056 nt lds
    s_waitcnt vmcnt(29)
    buffer_load_dwordx4 v30, s[28:31], s62 offen offset:2112 nt lds
    s_waitcnt vmcnt(29)
    buffer_load_dwordx4 v31, s[28:31], s62 offen offset:3168 nt lds
    s_add_u32 m0, s54, 12672
    s_waitcnt vmcnt(29)
    buffer_load_dwordx4 v28, s[28:31], s63 offen offset:0 nt lds
    s_waitcnt vmcnt(29)
    s_cmp_ge_u32 s50, 2
    s_cbranch_scc0 L_nbkb30
    s_lshl1_add_u32 s52, s50, -2
    v_mov_b32 v37, s52
    ds_write_b32 v36, v37 offset:16
L_nbkb30:
    buffer_load_dwordx4 v29, s[28:31], s63 offen offset:1056 nt lds
    s_waitcnt vmcnt(29)
    buffer_load_dwordx4 v30, s[28:31], s63 offen offset:2112 nt lds
    s_waitcnt vmcnt(29)
    buffer_load_dwordx4 v31, s[28:31], s63 offen offset:3168 nt lds
    s_branch L_drain
L_pro31:
    s_mov_b32 m0, 8704
    s_nop 0
    buffer_load_dwordx4 v24, s[24:27], s62 offen offset:0 nt lds
    buffer_load_dwordx4 v25, s[24:27], s62 offen offset:1088 nt lds
    buffer_load_dwordx4 v26, s[24:27], s62 offen offset:2176 nt lds
    buffer_load_dwordx4 v27, s[24:27], s62 offen offset:3264 nt lds
    s_mov_b32 m0, 13056
    s_nop 0
    buffer_load_dwordx4 v24, s[24:27], s63 offen offset:0 nt lds
    buffer_load_dwordx4 v25, s[24:27], s63 offen offset:1088 nt lds
    buffer_load_dwordx4 v26, s[24:27], s63 offen offset:2176 nt lds
    buffer_load_dwordx4 v27, s[24:27], s63 offen offset:3264 nt lds
    s_mov_b32 s53, 17408
    s_cmp_ge_u32 s50, s51
    s_cbranch_scc1 L_tail31
    s_mov_b32 m0, 17408
    s_nop 0
    buffer_load_dwordx4 v24, s[24:27], s56 offen offset:0 nt lds
    buffer_load_dwordx4 v25, s[24:27], s56 offen offset:1088 nt lds
    buffer_load_dwordx4 v26, s[24:27], s56 offen offset:2176 nt lds
    buffer_load_dwordx4 v27, s[24:27], s56 offen offset:3264 nt lds
    s_mov_b32 m0, 21760
    s_nop 0
    buffer_load_dwordx4 v24, s[24:27], s57 offen offset:0 nt lds
    buffer_load_dwordx4 v25, s[24:27], s57 offen offset:1088 nt lds
    buffer_load_dwordx4 v26, s[24:27], s57 offen offset:2176 nt lds
    buffer_load_dwordx4 v27, s[24:27], s57 offen offset:3264 nt lds
    s_mov_b32 m0, 26112
    s_nop 0
    buffer_load_dwordx4 v24, s[24:27], s58 offen offset:0 nt lds
    buffer_load_dwordx4 v25, s[24:27], s58 offen offset:1088 nt lds
    buffer_load_dwordx4 v26, s[24:27], s58 offen offset:2176 nt lds
    buffer_load_dwordx4 v27, s[24:27], s58 offen offset:3264 nt lds
    s_branch L_mid31
L_loop31:
    s_sub_i32 s48, s50, 3
    s_branch L_fchka31
L_fspina31:
    ds_read_b128 v[32:35], v36
L_fchka31:
    s_waitcnt lgkmcnt(0)
    v_min_u32 v32, v32, v33
    v_min3_u32 v32, v32, v34, v35
    s_nop 0
    v_readfirstlane_b32 s47, v32
    s_nop 0
    s_cmp_ge_i32 s47, s48
    s_cbranch_scc0 L_fspina31
    s_add_u32 m0, s53, 0
    s_waitcnt vmcnt(30)
    buffer_load_dwordx4 v24, s[24:27], s56 offen offset:0 nt lds
    s_waitcnt vmcnt(30)
    buffer_load_dwordx4 v25, s[24:27], s56 offen offset:1088 nt lds
    s_waitcnt vmcnt(30)
    buffer_load_dwordx4 v26, s[24:27], s56 offen offset:2176 nt lds
    s_waitcnt vmcnt(30)
    buffer_load_dwordx4 v27, s[24:27], s56 offen offset:3264 nt lds
    s_add_u32 m0, s53, 4352
    s_waitcnt vmcnt(30)
    buffer_load_dwordx4 v24, s[24:27], s57 offen offset:0 nt lds
    s_waitcnt vmcnt(30)
    buffer_load_dwordx4 v25, s[24:27], s57 offen offset:1088 nt lds
    s_waitcnt vmcnt(30)
    buffer_load_dwordx4 v26, s[24:27], s57 offen offset:2176 nt lds
    s_waitcnt vmcnt(30)
    buffer_load_dwordx4 v27, s[24:27], s57 offen offset:3264 nt lds
    s_add_u32 m0, s53, 8704
    s_waitcnt vmcnt(30)
    buffer_load_dwordx4 v24, s[24:27], s58 offen offset:0 nt lds
    s_waitcnt vmcnt(30)
    buffer_load_dwordx4 v25, s[24:27], s58 offen offset:1088 nt lds
    s_waitcnt vmcnt(30)
    buffer_load_dwordx4 v26, s[24:27], s58 offen offset:2176 nt lds
    s_waitcnt vmcnt(30)
    buffer_load_dwordx4 v27, s[24:27], s58 offen offset:3264 nt lds
L_mid31:
    s_add_u32 m0, s53, 13056
    s_waitcnt vmcnt(30)
    buffer_load_dwordx4 v24, s[24:27], s59 offen offset:0 nt lds
    s_waitcnt vmcnt(30)
    buffer_load_dwordx4 v25, s[24:27], s59 offen offset:1088 nt lds
    s_waitcnt vmcnt(30)
    s_cmp_ge_u32 s50, 2
    s_cbranch_scc0 L_nbka31
    s_lshl1_add_u32 s52, s50, -2
    v_mov_b32 v37, s52
    ds_write_b32 v36, v37 offset:16
L_nbka31:
    buffer_load_dwordx4 v26, s[24:27], s59 offen offset:2176 nt lds
    s_waitcnt vmcnt(30)
    buffer_load_dwordx4 v27, s[24:27], s59 offen offset:3264 nt lds
    s_add_u32 m0, s54, 0
    s_waitcnt vmcnt(30)
    buffer_load_dwordx4 v28, s[28:31], s60 offen offset:0 nt lds
    s_waitcnt vmcnt(30)
    buffer_load_dwordx4 v29, s[28:31], s60 offen offset:1056 nt lds
    s_waitcnt vmcnt(30)
    buffer_load_dwordx4 v30, s[28:31], s60 offen offset:2112 nt lds
    s_waitcnt vmcnt(30)
    buffer_load_dwordx4 v31, s[28:31], s60 offen offset:3168 nt lds
    s_add_u32 m0, s54, 4224
    s_waitcnt vmcnt(30)
    buffer_load_dwordx4 v28, s[28:31], s61 offen offset:0 nt lds
    s_waitcnt vmcnt(30)
    buffer_load_dwordx4 v29, s[28:31], s61 offen offset:1056 nt lds
    s_waitcnt vmcnt(30)
    buffer_load_dwordx4 v30, s[28:31], s61 offen offset:2112 nt lds
    s_waitcnt vmcnt(30)
    buffer_load_dwordx4 v31, s[28:31], s61 offen offset:3168 nt lds
    s_add_u32 m0, s54, 8448
    s_waitcnt vmcnt(30)
    buffer_load_dwordx4 v28, s[28:31], s62 offen offset:0 nt lds
    s_waitcnt vmcnt(30)
    buffer_load_dwordx4 v29, s[28:31], s62 offen offset:1056 nt lds
    s_waitcnt vmcnt(30)
    buffer_load_dwordx4 v30, s[28:31], s62 offen offset:2112 nt lds
    s_waitcnt vmcnt(30)
    ds_read_b128 v[32:35], v36
    buffer_load_dwordx4 v31, s[28:31], s62 offen offset:3168 nt lds
    s_add_u32 m0, s54, 12672
    s_waitcnt vmcnt(30)
    buffer_load_dwordx4 v28, s[28:31], s63 offen offset:0 nt lds
    s_waitcnt vmcnt(30)
    buffer_load_dwordx4 v29, s[28:31], s63 offen offset:1056 nt lds
    s_waitcnt vmcnt(30)
    s_lshl1_add_u32 s52, s50, -1
    v_mov_b32 v37, s52
    ds_write_b32 v36, v37 offset:16
    buffer_load_dwordx4 v30, s[28:31], s63 offen offset:2112 nt lds
    s_waitcnt vmcnt(30)
    buffer_load_dwordx4 v31, s[28:31], s63 offen offset:3168 nt lds
    s_add_u32 s50, s50, 1
    s_mov_b64 s[60:61], s[56:57]
    s_mov_b64 s[62:63], s[58:59]
    s_cmp_eq_u32 s50, 2
    s_cbranch_scc0 L_tab31
L_tw31:
    ds_read_b128 v[40:43], v36 offset:32
    ds_read_b128 v[20:23], v39
    s_waitcnt lgkmcnt(0)
    v_min3_u32 v40, v40, v41, v42
    v_min_u32 v40, v40, v43
    s_nop 0
    v_readfirstlane_b32 s47, v40
    s_nop 0
    s_cmp_eq_u32 s47, 0
    s_cbranch_scc1 L_tw31
L_tab31:
    v_readlane_b32 s56, v20, s50
    v_readlane_b32 s57, v21, s50
    v_readlane_b32 s58, v22, s50
    v_readlane_b32 s59, v23, s50
    s_add_u32 s53, s53, 17408
    s_cmp_ge_u32 s53, 69632
    s_cselect_b32 s53, 0, s53
    s_add_u32 s54, s54, 16896
    s_cmp_ge_u32 s54, 137216
    s_cselect_b32 s54, 69632, s54
    s_cmp_lt_u32 s50, s51
    s_cbranch_scc1 L_loop31
L_tail31:
    s_sub_i32 s48, s50, 3
    s_branch L_fchkb31
L_fspinb31:
    ds_read_b128 v[32:35], v36
L_fchkb31:
    s_waitcnt lgkmcnt(0)
    v_min_u32 v32, v32, v33
    v_min3_u32 v32, v32, v34, v35
    s_nop 0
    v_readfirstlane_b32 s47, v32
    s_nop 0
    s_cmp_ge_i32 s47, s48
    s_cbranch_scc0 L_fspinb31
    s_add_u32 m0, s54, 0
    s_waitcnt vmcnt(30)
    buffer_load_dwordx4 v28, s[28:31], s60 offen offset:0 nt lds
    s_waitcnt vmcnt(30)
    buffer_load_dwordx4 v29, s[28:31], s60 offen offset:1056 nt lds
    s_waitcnt vmcnt(30)
    buffer_load_dwordx4 v30, s[28:31], s60 offen offset:2112 nt lds
    s_waitcnt vmcnt(30)
    buffer_load_dwordx4 v31, s[28:31], s60 offen offset:3168 nt lds
    s_add_u32 m0, s54, 4224
    s_waitcnt vmcnt(30)
    buffer_load_dwordx4 v28, s[28:31], s61 offen offset:0 nt lds
    s_waitcnt vmcnt(30)
    buffer_load_dwordx4 v29, s[28:31], s61 offen offset:1056 nt lds
    s_waitcnt vmcnt(30)
    buffer_load_dwordx4 v30, s[28:31], s61 offen offset:2112 nt lds
    s_waitcnt vmcnt(30)
    buffer_load_dwordx4 v31, s[28:31], s61 offen offset:3168 nt lds
    s_add_u32 m0, s54, 8448
    s_waitcnt vmcnt(30)
    buffer_load_dwordx4 v28, s[28:31], s62 offen offset:0 nt lds
    s_waitcnt vmcnt(30)
    buffer_load_dwordx4 v29, s[28:31], s62 offen offset:1056 nt lds
    s_waitcnt vmcnt(30)
    buffer_load_dwordx4 v30, s[28:31], s62 offen offset:2112 nt lds
    s_waitcnt vmcnt(30)
    buffer_load_dwordx4 v31, s[28:31], s62 offen offset:3168 nt lds
    s_add_u32 m0, s54, 12672
    s_waitcnt vmcnt(30)
    buffer_load_dwordx4 v28, s[28:31], s63 offen offset:0 nt lds
    s_waitcnt vmcnt(30)
    buffer_load_dwordx4 v29, s[28:31], s63 offen offset:1056 nt lds
    s_waitcnt vmcnt(30)
    s_cmp_ge_u32 s50, 2
    s_cbranch_scc0 L_nbkb31
    s_lshl1_add_u32 s52, s50, -2
    v_mov_b32 v37, s52
    ds_write_b32 v36, v37 offset:16
L_nbkb31:
    buffer_load_dwordx4 v30, s[28:31], s63 offen offset:2112 nt lds
    s_waitcnt vmcnt(30)
    buffer_load_dwordx4 v31, s[28:31], s63 offen offset:3168 nt lds
    s_branch L_drain
L_pro32:
    s_mov_b32 m0, 8704
    s_nop 0
    buffer_load_dwordx4 v24, s[24:27], s62 offen offset:0 nt lds
    buffer_load_dwordx4 v25, s[24:27], s62 offen offset:1088 nt lds
    buffer_load_dwordx4 v26, s[24:27], s62 offen offset:2176 nt lds
    buffer_load_dwordx4 v27, s[24:27], s62 offen offset:3264 nt lds
    s_mov_b32 m0, 13056
    s_nop 0
    buffer_load_dwordx4 v24, s[24:27], s63 offen offset:0 nt lds
    buffer_load_dwordx4 v25, s[24:27], s63 offen offset:1088 nt lds
    buffer_load_dwordx4 v26, s[24:27], s63 offen offset:2176 nt lds
    buffer_load_dwordx4 v27, s[24:27], s63 offen offset:3264 nt lds
    s_mov_b32 s53, 17408
    s_cmp_ge_u32 s50, s51
    s_cbranch_scc1 L_tail32
    s_mov_b32 m0, 17408
    s_nop 0
    buffer_load_dwordx4 v24, s[24:27], s56 offen offset:0 nt lds
    buffer_load_dwordx4 v25, s[24:27], s56 offen offset:1088 nt lds
    buffer_load_dwordx4 v26, s[24:27], s56 offen offset:2176 nt lds
    buffer_load_dwordx4 v27, s[24:27], s56 offen offset:3264 nt lds
    s_mov_b32 m0, 21760
    s_nop 0
    buffer_load_dwordx4 v24, s[24:27], s57 offen offset:0 nt lds
    buffer_load_dwordx4 v25, s[24:27], s57 offen offset:1088 nt lds
    buffer_load_dwordx4 v26, s[24:27], s57 offen offset:2176 nt lds
    buffer_load_dwordx4 v27, s[24:27], s57 offen offset:3264 nt lds
    s_mov_b32 m0, 26112
    s_nop 0
    buffer_load_dwordx4 v24, s[24:27], s58 offen offset:0 nt lds
    buffer_load_dwordx4 v25, s[24:27], s58 offen offset:1088 nt lds
    buffer_load_dwordx4 v26, s[24:27], s58 offen offset:2176 nt lds
    buffer_load_dwordx4 v27, s[24:27], s58 offen offset:3264 nt lds
    s_mov_b32 m0, 30464
    s_nop 0
    buffer_load_dwordx4 v24, s[24:27], s59 offen offset:0 nt lds
    buffer_load_dwordx4 v25, s[24:27], s59 offen offset:1088 nt lds
    buffer_load_dwordx4 v26, s[24:27], s59 offen offset:2176 nt lds
    buffer_load_dwordx4 v27, s[24:27], s59 offen offset:3264 nt lds
    s_branch L_mid32
L_loop32:
    s_sub_i32 s48, s50, 3
    s_branch L_fchka32
L_fspina32:
    ds_read_b128 v[32:35], v36
L_fchka32:
    s_waitcnt lgkmcnt(0)
    v_min_u32 v32, v32, v33
    v_min3_u32 v32, v32, v34, v35
    s_nop 0
    v_readfirstlane_b32 s47, v32
    s_nop 0
    s_cmp_ge_i32 s47, s48
    s_cbranch_scc0 L_fspina32
    s_add_u32 m0, s53, 0
    s_waitcnt vmcnt(31)
    buffer_load_dwordx4 v24, s[24:27], s56 offen offset:0 nt lds
    s_waitcnt vmcnt(31)
    buffer_load_dwordx4 v25, s[24:27], s56 offen offset:1088 nt lds
    s_waitcnt vmcnt(31)
    buffer_load_dwordx4 v26, s[24:27], s56 offen offset:2176 nt lds
    s_waitcnt vmcnt(31)
    buffer_load_dwordx4 v27, s[24:27], s56 offen offset:3264 nt lds
    s_add_u32 m0, s53, 4352
    s_waitcnt vmcnt(31)
    buffer_load_dwordx4 v24, s[24:27], s57 offen offset:0 nt lds
    s_waitcnt vmcnt(31)
    buffer_load_dwordx4 v25, s[24:27], s57 offen offset:1088 nt lds
    s_waitcnt vmcnt(31)
    buffer_load_dwordx4 v26, s[24:27], s57 offen offset:2176 nt lds
    s_waitcnt vmcnt(31)
    buffer_load_dwordx4 v27, s[24:27], s57 offen offset:3264 nt lds
    s_add_u32 m0, s53, 8704
    s_waitcnt vmcnt(31)
    buffer_load_dwordx4 v24, s[24:27], s58 offen offset:0 nt lds
    s_waitcnt vmcnt(31)
    buffer_load_dwordx4 v25, s[24:27], s58 offen offset:1088 nt lds
    s_waitcnt vmcnt(31)
    buffer_load_dwordx4 v26, s[24:27], s58 offen offset:2176 nt lds
    s_waitcnt vmcnt(31)
    buffer_load_dwordx4 v27, s[24:27], s58 offen offset:3264 nt lds
    s_add_u32 m0, s53, 13056
    s_waitcnt vmcnt(31)
    buffer_load_dwordx4 v24, s[24:27], s59 offen offset:0 nt lds
    s_waitcnt vmcnt(31)
    buffer_load_dwordx4 v25, s[24:27], s59 offen offset:1088 nt lds
    s_waitcnt vmcnt(31)
    buffer_load_dwordx4 v26, s[24:27], s59 offen offset:2176 nt lds
    s_waitcnt vmcnt(31)
    s_cmp_ge_u32 s50, 2
    s_cbranch_scc0 L_nbka32
    s_lshl1_add_u32 s52, s50, -2
    v_mov_b32 v37, s52
    ds_write_b32 v36, v37 offset:16
L_nbka32:
    buffer_load_dwordx4 v27, s[24:27], s59 offen offset:3264 nt lds
L_mid32:
    s_add_u32 m0, s54, 0
    s_waitcnt vmcnt(31)
    buffer_load_dwordx4 v28, s[28:31], s60 offen offset:0 nt lds
    s_waitcnt vmcnt(31)
    buffer_load_dwordx4 v29, s[28:31], s60 offen offset:1056 nt lds
    s_waitcnt vmcnt(31)
    buffer_load_dwordx4 v30, s[28:31], s60 offen offset:2112 nt lds
    s_waitcnt vmcnt(31)
    buffer_load_dwordx4 v31, s[28:31], s60 offen offset:3168 nt lds
    s_add_u32 m0, s54, 4224
    s_waitcnt vmcnt(31)
    buffer_load_dwordx4 v28, s[28:31], s61 offen offset:0 nt lds
    s_waitcnt vmcnt(31)
    buffer_load_dwordx4 v29, s[28:31], s61 offen offset:1056 nt lds
    s_waitcnt vmcnt(31)
    buffer_load_dwordx4 v30, s[28:31], s61 offen offset:2112 nt lds
    s_waitcnt vmcnt(31)
    buffer_load_dwordx4 v31, s[28:31], s61 offen offset:3168 nt lds
    s_add_u32 m0, s54, 8448
    s_waitcnt vmcnt(31)
    buffer_load_dwordx4 v28, s[28:31], s62 offen offset:0 nt lds
    s_waitcnt vmcnt(31)
    buffer_load_dwordx4 v29, s[28:31], s62 offen offset:1056 nt lds
    s_waitcnt vmcnt(31)
    buffer_load_dwordx4 v30, s[28:31], s62 offen offset:2112 nt lds
    s_waitcnt vmcnt(31)
    ds_read_b128 v[32:35], v36
    buffer_load_dwordx4 v31, s[28:31], s62 offen offset:3168 nt lds
    s_add_u32 m0, s54, 12672
    s_waitcnt vmcnt(31)
    buffer_load_dwordx4 v28, s[28:31], s63 offen offset:0 nt lds
    s_waitcnt vmcnt(31)
    buffer_load_dwordx4 v29, s[28:31], s63 offen offset:1056 nt lds
    s_waitcnt vmcnt(31)
    buffer_load_dwordx4 v30, s[28:31], s63 offen offset:2112 nt lds
    s_waitcnt vmcnt(31)
    s_lshl1_add_u32 s52, s50, -1
    v_mov_b32 v37, s52
    ds_write_b32 v36, v37 offset:16
    buffer_load_dwordx4 v31, s[28:31], s63 offen offset:3168 nt lds
    s_add_u32 s50, s50, 1
    s_mov_b64 s[60:61], s[56:57]
    s_mov_b64 s[62:63], s[58:59]
    s_cmp_eq_u32 s50, 2
    s_cbranch_scc0 L_tab32
L_tw32:
    ds_read_b128 v[40:43], v36 offset:32
    ds_read_b128 v[20:23], v39
    s_waitcnt lgkmcnt(0)
    v_min3_u32 v40, v40, v41, v42
    v_min_u32 v40, v40, v43
    s_nop 0
    v_readfirstlane_b32 s47, v40
    s_nop 0
    s_cmp_eq_u32 s47, 0
    s_cbranch_scc1 L_tw32
L_tab32:
    v_readlane_b32 s56, v20, s50
    v_readlane_b32 s57, v21, s50
    v_readlane_b32 s58, v22, s50
    v_readlane_b32 s59, v23, s50
    s_add_u32 s53, s53, 17408
    s_cmp_ge_u32 s53, 69632
    s_cselect_b32 s53, 0, s53
    s_add_u32 s54, s54, 16896
    s_cmp_ge_u32 s54, 137216
    s_cselect_b32 s54, 69632, s54
    s_cmp_lt_u32 s50, s51
    s_cbranch_scc1 L_loop32
L_tail32:
    s_sub_i32 s48, s50, 3
    s_branch L_fchkb32
L_fspinb32:
    ds_read_b128 v[32:35], v36
L_fchkb32:
    s_waitcnt lgkmcnt(0)
    v_min_u32 v32, v32, v33
    v_min3_u32 v32, v32, v34, v35
    s_nop 0
    v_readfirstlane_b32 s47, v32
    s_nop 0
    s_cmp_ge_i32 s47, s48
    s_cbranch_scc0 L_fspinb32
    s_add_u32 m0, s54, 0
    s_waitcnt vmcnt(31)
    buffer_load_dwordx4 v28, s[28:31], s60 offen offset:0 nt lds
    s_waitcnt vmcnt(31)
    buffer_load_dwordx4 v29, s[28:31], s60 offen offset:1056 nt lds
    s_waitcnt vmcnt(31)
    buffer_load_dwordx4 v30, s[28:31], s60 offen offset:2112 nt lds
    s_waitcnt vmcnt(31)
    buffer_load_dwordx4 v31, s[28:31], s60 offen offset:3168 nt lds
    s_add_u32 m0, s54, 4224
    s_waitcnt vmcnt(31)
    buffer_load_dwordx4 v28, s[28:31], s61 offen offset:0 nt lds
    s_waitcnt vmcnt(31)
    buffer_load_dwordx4 v29, s[28:31], s61 offen offset:1056 nt lds
    s_waitcnt vmcnt(31)
    buffer_load_dwordx4 v30, s[28:31], s61 offen offset:2112 nt lds
    s_waitcnt vmcnt(31)
    buffer_load_dwordx4 v31, s[28:31], s61 offen offset:3168 nt lds
    s_add_u32 m0, s54, 8448
    s_waitcnt vmcnt(31)
    buffer_load_dwordx4 v28, s[28:31], s62 offen offset:0 nt lds
    s_waitcnt vmcnt(31)
    buffer_load_dwordx4 v29, s[28:31], s62 offen offset:1056 nt lds
    s_waitcnt vmcnt(31)
    buffer_load_dwordx4 v30, s[28:31], s62 offen offset:2112 nt lds
    s_waitcnt vmcnt(31)
    buffer_load_dwordx4 v31, s[28:31], s62 offen offset:3168 nt lds
    s_add_u32 m0, s54, 12672
    s_waitcnt vmcnt(31)
    buffer_load_dwordx4 v28, s[28:31], s63 offen offset:0 nt lds
    s_waitcnt vmcnt(31)
    buffer_load_dwordx4 v29, s[28:31], s63 offen offset:1056 nt lds
    s_waitcnt vmcnt(31)
    buffer_load_dwordx4 v30, s[28:31], s63 offen offset:2112 nt lds
    s_waitcnt vmcnt(31)
    s_cmp_ge_u32 s50, 2
    s_cbranch_scc0 L_nbkb32
    s_lshl1_add_u32 s52, s50, -2
    v_mov_b32 v37, s52
    ds_write_b32 v36, v37 offset:16
L_nbkb32:
    buffer_load_dwordx4 v31, s[28:31], s63 offen offset:3168 nt lds
    s_branch L_drain
L_pro33:
    s_mov_b32 m0, 8704
    s_nop 0
    buffer_load_dwordx4 v24, s[24:27], s62 offen offset:0 nt lds
    buffer_load_dwordx4 v25, s[24:27], s62 offen offset:1088 nt lds
    buffer_load_dwordx4 v26, s[24:27], s62 offen offset:2176 nt lds
    buffer_load_dwordx4 v27, s[24:27], s62 offen offset:3264 nt lds
    s_mov_b32 m0, 13056
    s_nop 0
    buffer_load_dwordx4 v24, s[24:27], s63 offen offset:0 nt lds
    buffer_load_dwordx4 v25, s[24:27], s63 offen offset:1088 nt lds
    buffer_load_dwordx4 v26, s[24:27], s63 offen offset:2176 nt lds
    buffer_load_dwordx4 v27, s[24:27], s63 offen offset:3264 nt lds
    s_mov_b32 s53, 17408
    s_cmp_ge_u32 s50, s51
    s_cbranch_scc1 L_tail33
    s_mov_b32 m0, 17408
    s_nop 0
    buffer_load_dwordx4 v24, s[24:27], s56 offen offset:0 nt lds
    buffer_load_dwordx4 v25, s[24:27], s56 offen offset:1088 nt lds
    buffer_load_dwordx4 v26, s[24:27], s56 offen offset:2176 nt lds
    buffer_load_dwordx4 v27, s[24:27], s56 offen offset:3264 nt lds
    s_mov_b32 m0, 21760
    s_nop 0
    buffer_load_dwordx4 v24, s[24:27], s57 offen offset:0 nt lds
    buffer_load_dwordx4 v25, s[24:27], s57 offen offset:1088 nt lds
    buffer_load_dwordx4 v26, s[24:27], s57 offen offset:2176 nt lds
    buffer_load_dwordx4 v27, s[24:27], s57 offen offset:3264 nt lds
    s_mov_b32 m0, 26112
    s_nop 0
    buffer_load_dwordx4 v24, s[24:27], s58 offen offset:0 nt lds
    buffer_load_dwordx4 v25, s[24:27], s58 offen offset:1088 nt lds
    buffer_load_dwordx4 v26, s[24:27], s58 offen offset:2176 nt lds
    buffer_load_dwordx4 v27, s[24:27], s58 offen offset:3264 nt lds
    s_mov_b32 m0, 30464
    s_nop 0
    buffer_load_dwordx4 v24, s[24:27], s59 offen offset:0 nt lds
    buffer_load_dwordx4 v25, s[24:27], s59 offen offset:1088 nt lds
    buffer_load_dwordx4 v26, s[24:27], s59 offen offset:2176 nt lds
    buffer_load_dwordx4 v27, s[24:27], s59 offen offset:3264 nt lds
    s_branch L_mid33
L_loop33:
    s_sub_i32 s48, s50, 3
    s_branch L_fchka33
L_fspina33:
    ds_read_b128 v[32:35], v36
L_fchka33:
    s_waitcnt lgkmcnt(0)
    v_min_u32 v32, v32, v33
    v_min3_u32 v32, v32, v34, v35
    s_nop 0
    v_readfirstlane_b32 s47, v32
    s_nop 0
    s_cmp_ge_i32 s47, s48
    s_cbranch_scc0 L_fspina33
    s_add_u32 m0, s53, 0
    s_waitcnt vmcnt(32)
    s_cmp_ge_u32 s50, 2
    s_cbranch_scc0 L_nbva33
    s_lshl1_add_u32 s52, s50, -3
    v_mov_b32 v37, s52
    ds_write_b32 v36, v37 offset:16
L_nbva33:
    buffer_load_dwordx4 v24, s[24:27], s56 offen offset:0 nt lds
    s_waitcnt vmcnt(32)
    buffer_load_dwordx4 v25, s[24:27], s56 offen offset:1088 nt lds
    s_waitcnt vmcnt(32)
    buffer_load_dwordx4 v26, s[24:27], s56 offen offset:2176 nt lds
    s_waitcnt vmcnt(32)
    buffer_load_dwordx4 v27, s[24:27], s56 offen offset:3264 nt lds
    s_add_u32 m0, s53, 4352
    s_waitcnt vmcnt(32)
    buffer_load_dwordx4 v24, s[24:27], s57 offen offset:0 nt lds
    s_waitcnt vmcnt(32)
    buffer_load_dwordx4 v25, s[24:27], s57 offen offset:1088 nt lds
    s_waitcnt vmcnt(32)
    buffer_load_dwordx4 v26, s[24:27], s57 offen offset:2176 nt lds
    s_waitcnt vmcnt(32)
    buffer_load_dwordx4 v27, s[24:27], s57 offen offset:3264 nt lds
    s_add_u32 m0, s53, 8704
    s_waitcnt vmcnt(32)
    buffer_load_dwordx4 v24, s[24:27], s58 offen offset:0 nt lds
    s_waitcnt vmcnt(32)
    buffer_load_dwordx4 v25, s[24:27], s58 offen offset:1088 nt lds
    s_waitcnt vmcnt(32)
    buffer_load_dwordx4 v26, s[24:27], s58 offen offset:2176 nt lds
    s_waitcnt vmcnt(32)
    buffer_load_dwordx4 v27, s[24:27], s58 offen offset:3264 nt lds
    s_add_u32 m0, s53, 13056
    s_waitcnt vmcnt(32)
    buffer_load_dwordx4 v24, s[24:27], s59 offen offset:0 nt lds
    s_waitcnt vmcnt(32)
    buffer_load_dwordx4 v25, s[24:27], s59 offen offset:1088 nt lds
    s_waitcnt vmcnt(32)
    buffer_load_dwordx4 v26, s[24:27], s59 offen offset:2176 nt lds
    s_waitcnt vmcnt(32)
    buffer_load_dwordx4 v27, s[24:27], s59 offen offset:3264 nt lds
L_mid33:
    s_add_u32 m0, s54, 0
    s_waitcnt vmcnt(32)
    s_cmp_ge_u32 s50, 2
    s_cbranch_scc0 L_nbka33
    s_lshl1_add_u32 s52, s50, -2
    v_mov_b32 v37, s52
    ds_write_b32 v36, v37 offset:16
L_nbka33:
    buffer_load_dwordx4 v28, s[28:31], s60 offen offset:0 nt lds
    s_waitcnt vmcnt(32)
    buffer_load_dwordx4 v29, s[28:31], s60 offen offset:1056 nt lds
    s_waitcnt vmcnt(32)
    buffer_load_dwordx4 v30, s[28:31], s60 offen offset:2112 nt lds
    s_waitcnt vmcnt(32)
    buffer_load_dwordx4 v31, s[28:31], s60 offen offset:3168 nt lds
    s_add_u32 m0, s54, 4224
    s_waitcnt vmcnt(32)
    buffer_load_dwordx4 v28, s[28:31], s61 offen offset:0 nt lds
    s_waitcnt vmcnt(32)
    buffer_load_dwordx4 v29, s[28:31], s61 offen offset:1056 nt lds
    s_waitcnt vmcnt(32)
    buffer_load_dwordx4 v30, s[28:31], s61 offen offset:2112 nt lds
    s_waitcnt vmcnt(32)
    buffer_load_dwordx4 v31, s[28:31], s61 offen offset:3168 nt lds
    s_add_u32 m0, s54, 8448
    s_waitcnt vmcnt(32)
    buffer_load_dwordx4 v28, s[28:31], s62 offen offset:0 nt lds
    s_waitcnt vmcnt(32)
    buffer_load_dwordx4 v29, s[28:31], s62 offen offset:1056 nt lds
    s_waitcnt vmcnt(32)
    buffer_load_dwordx4 v30, s[28:31], s62 offen offset:2112 nt lds
    s_waitcnt vmcnt(32)
    ds_read_b128 v[32:35], v36
    buffer_load_dwordx4 v31, s[28:31], s62 offen offset:3168 nt lds
    s_add_u32 m0, s54, 12672
    s_waitcnt vmcnt(32)
    buffer_load_dwordx4 v28, s[28:31], s63 offen offset:0 nt lds
    s_waitcnt vmcnt(32)
    buffer_load_dwordx4 v29, s[28:31], s63 offen offset:1056 nt lds
    s_waitcnt vmcnt(32)
    buffer_load_dwordx4 v30, s[28:31], s63 offen offset:2112 nt lds
    s_waitcnt vmcnt(32)
    buffer_load_dwordx4 v31, s[28:31], s63 offen offset:3168 nt lds
    s_add_u32 s50, s50, 1
    s_mov_b64 s[60:61], s[56:57]
    s_mov_b64 s[62:63], s[58:59]
    s_cmp_eq_u32 s50, 2
    s_cbranch_scc0 L_tab33
L_tw33:
    ds_read_b128 v[40:43], v36 offset:32
    ds_read_b128 v[20:23], v39
    s_waitcnt lgkmcnt(0)
    v_min3_u32 v40, v40, v41, v42
    v_min_u32 v40, v40, v43
    s_nop 0
    v_readfirstlane_b32 s47, v40
    s_nop 0
    s_cmp_eq_u32 s47, 0
    s_cbranch_scc1 L_tw33
L_tab33:
    v_readlane_b32 s56, v20, s50
    v_readlane_b32 s57, v21, s50
    v_readlane_b32 s58, v22, s50
    v_readlane_b32 s59, v23, s50
    s_add_u32 s53, s53, 17408
    s_cmp_ge_u32 s53, 69632
    s_cselect_b32 s53, 0, s53
    s_add_u32 s54, s54, 16896
    s_cmp_ge_u32 s54, 137216
    s_cselect_b32 s54, 69632, s54
    s_cmp_lt_u32 s50, s51
    s_cbranch_scc1 L_loop33
L_tail33:
    s_sub_i32 s48, s50, 3
    s_branch L_fchkb33
L_fspinb33:
    ds_read_b128 v[32:35], v36
L_fchkb33:
    s_waitcnt lgkmcnt(0)
    v_min_u32 v32, v32, v33
    v_min3_u32 v32, v32, v34, v35
    s_nop 0
    v_readfirstlane_b32 s47, v32
    s_nop 0
    s_cmp_ge_i32 s47, s48
    s_cbranch_scc0 L_fspinb33
    s_add_u32 m0, s54, 0
    s_waitcnt vmcnt(32)
    s_cmp_ge_u32 s50, 2
    s_cbranch_scc0 L_nbvb33
    s_lshl1_add_u32 s52, s50, -3
    v_mov_b32 v37, s52
    ds_write_b32 v36, v37 offset:16
L_nbvb33:
    buffer_load_dwordx4 v28, s[28:31], s60 offen offset:0 nt lds
    s_waitcnt vmcnt(32)
    buffer_load_dwordx4 v29, s[28:31], s60 offen offset:1056 nt lds
    s_waitcnt vmcnt(32)
    buffer_load_dwordx4 v30, s[28:31], s60 offen offset:2112 nt lds
    s_waitcnt vmcnt(32)
    buffer_load_dwordx4 v31, s[28:31], s60 offen offset:3168 nt lds
    s_add_u32 m0, s54, 4224
    s_waitcnt vmcnt(32)
    buffer_load_dwordx4 v28, s[28:31], s61 offen offset:0 nt lds
    s_waitcnt vmcnt(32)
    buffer_load_dwordx4 v29, s[28:31], s61 offen offset:1056 nt lds
    s_waitcnt vmcnt(32)
    buffer_load_dwordx4 v30, s[28:31], s61 offen offset:2112 nt lds
    s_waitcnt vmcnt(32)
    buffer_load_dwordx4 v31, s[28:31], s61 offen offset:3168 nt lds
    s_add_u32 m0, s54, 8448
    s_waitcnt vmcnt(32)
    buffer_load_dwordx4 v28, s[28:31], s62 offen offset:0 nt lds
    s_waitcnt vmcnt(32)
    buffer_load_dwordx4 v29, s[28:31], s62 offen offset:1056 nt lds
    s_waitcnt vmcnt(32)
    buffer_load_dwordx4 v30, s[28:31], s62 offen offset:2112 nt lds
    s_waitcnt vmcnt(32)
    buffer_load_dwordx4 v31, s[28:31], s62 offen offset:3168 nt lds
    s_add_u32 m0, s54, 12672
    s_waitcnt vmcnt(32)
    buffer_load_dwordx4 v28, s[28:31], s63 offen offset:0 nt lds
    s_waitcnt vmcnt(32)
    buffer_load_dwordx4 v29, s[28:31], s63 offen offset:1056 nt lds
    s_waitcnt vmcnt(32)
    buffer_load_dwordx4 v30, s[28:31], s63 offen offset:2112 nt lds
    s_waitcnt vmcnt(32)
    buffer_load_dwordx4 v31, s[28:31], s63 offen offset:3168 nt lds
    s_branch L_drain
L_pro34:
    s_mov_b32 m0, 8704
    s_nop 0
    buffer_load_dwordx4 v24, s[24:27], s62 offen offset:0 nt lds
    buffer_load_dwordx4 v25, s[24:27], s62 offen offset:1088 nt lds
    buffer_load_dwordx4 v26, s[24:27], s62 offen offset:2176 nt lds
    buffer_load_dwordx4 v27, s[24:27], s62 offen offset:3264 nt lds
    s_mov_b32 m0, 13056
    s_nop 0
    buffer_load_dwordx4 v24, s[24:27], s63 offen offset:0 nt lds
    buffer_load_dwordx4 v25, s[24:27], s63 offen offset:1088 nt lds
    buffer_load_dwordx4 v26, s[24:27], s63 offen offset:2176 nt lds
    buffer_load_dwordx4 v27, s[24:27], s63 offen offset:3264 nt lds
    s_mov_b32 s53, 17408
    s_cmp_ge_u32 s50, s51
    s_cbranch_scc1 L_tail34
    s_mov_b32 m0, 17408
    s_nop 0
    buffer_load_dwordx4 v24, s[24:27], s56 offen offset:0 nt lds
    buffer_load_dwordx4 v25, s[24:27], s56 offen offset:1088 nt lds
    buffer_load_dwordx4 v26, s[24:27], s56 offen offset:2176 nt lds
    buffer_load_dwordx4 v27, s[24:27], s56 offen offset:3264 nt lds
    s_mov_b32 m0, 21760
    s_nop 0
    buffer_load_dwordx4 v24, s[24:27], s57 offen offset:0 nt lds
    buffer_load_dwordx4 v25, s[24:27], s57 offen offset:1088 nt lds
    buffer_load_dwordx4 v26, s[24:27], s57 offen offset:2176 nt lds
    buffer_load_dwordx4 v27, s[24:27], s57 offen offset:3264 nt lds
    s_mov_b32 m0, 26112
    s_nop 0
    buffer_load_dwordx4 v24, s[24:27], s58 offen offset:0 nt lds
    buffer_load_dwordx4 v25, s[24:27], s58 offen offset:1088 nt lds
    buffer_load_dwordx4 v26, s[24:27], s58 offen offset:2176 nt lds
    buffer_load_dwordx4 v27, s[24:27], s58 offen offset:3264 nt lds
    s_mov_b32 m0, 30464
    s_nop 0
    buffer_load_dwordx4 v24, s[24:27], s59 offen offset:0 nt lds
    buffer_load_dwordx4 v25, s[24:27], s59 offen offset:1088 nt lds
    buffer_load_dwordx4 v26, s[24:27], s59 offen offset:2176 nt lds
    buffer_load_dwordx4 v27, s[24:27], s59 offen offset:3264 nt lds
    s_branch L_mid34
L_loop34:
    s_sub_i32 s48, s50, 3
    s_branch L_fchka34
L_fspina34:
    ds_read_b128 v[32:35], v36
L_fchka34:
    s_waitcnt lgkmcnt(0)
    v_min_u32 v32, v32, v33
    v_min3_u32 v32, v32, v34, v35
    s_nop 0
    v_readfirstlane_b32 s47, v32
    s_nop 0
    s_cmp_ge_i32 s47, s48
    s_cbranch_scc0 L_fspina34
    s_add_u32 m0, s53, 0
    s_waitcnt vmcnt(33)
    buffer_load_dwordx4 v24, s[24:27], s56 offen offset:0 nt lds
    s_waitcnt vmcnt(33)
    s_cmp_ge_u32 s50, 2
    s_cbranch_scc0 L_nbva34
    s_lshl1_add_u32 s52, s50, -3
    v_mov_b32 v37, s52
    ds_write_b32 v36, v37 offset:16
L_nbva34:
    buffer_load_dwordx4 v25, s[24:27], s56 offen offset:1088 nt lds
    s_waitcnt vmcnt(33)
    buffer_load_dwordx4 v26, s[24:27], s56 offen offset:2176 nt lds
    s_waitcnt vmcnt(33)
    buffer_load_dwordx4 v27, s[24:27], s56 offen offset:3264 nt lds
    s_add_u32 m0, s53, 4352
    s_waitcnt vmcnt(33)
    buffer_load_dwordx4 v24, s[24:27], s57 offen offset:0 nt lds
    s_waitcnt vmcnt(33)
    buffer_load_dwordx4 v25, s[24:27], s57 offen offset:1088 nt lds
    s_waitcnt vmcnt(33)
    buffer_load_dwordx4 v26, s[24:27], s57 offen offset:2176 nt lds
    s_waitcnt vmcnt(33)
    buffer_load_dwordx4 v27, s[24:27], s57 offen offset:3264 nt lds
    s_add_u32 m0, s53, 8704
    s_waitcnt vmcnt(33)
    buffer_load_dwordx4 v24, s[24:27], s58 offen offset:0 nt lds
    s_waitcnt vmcnt(33)
    buffer_load_dwordx4 v25, s[24:27], s58 offen offset:1088 nt lds
    s_waitcnt vmcnt(33)
    buffer_load_dwordx4 v26, s[24:27], s58 offen offset:2176 nt lds
    s_waitcnt vmcnt(33)
    buffer_load_dwordx4 v27, s[24:27], s58 offen offset:3264 nt lds
    s_add_u32 m0, s53, 13056
    s_waitcnt vmcnt(33)
    buffer_load_dwordx4 v24, s[24:27], s59 offen offset:0 nt lds
    s_waitcnt vmcnt(33)
    buffer_load_dwordx4 v25, s[24:27], s59 offen offset:1088 nt lds
    s_waitcnt vmcnt(33)
    buffer_load_dwordx4 v26, s[24:27], s59 offen offset:2176 nt lds
    s_waitcnt vmcnt(33)
    buffer_load_dwordx4 v27, s[24:27], s59 offen offset:3264 nt lds
L_mid34:
    s_add_u32 m0, s54, 0
    s_waitcnt vmcnt(33)
    buffer_load_dwordx4 v28, s[28:31], s60 offen offset:0 nt lds
    s_waitcnt vmcnt(33)
    s_cmp_ge_u32 s50, 2
    s_cbranch_scc0 L_nbka34
    s_lshl1_add_u32 s52, s50, -2
    v_mov_b32 v37, s52
    ds_write_b32 v36, v37 offset:16
L_nbka34:
    buffer_load_dwordx4 v29, s[28:31], s60 offen offset:1056 nt lds
    s_waitcnt vmcnt(33)
    buffer_load_dwordx4 v30, s[28:31], s60 offen offset:2112 nt lds
    s_waitcnt vmcnt(33)
    buffer_load_dwordx4 v31, s[28:31], s60 offen offset:3168 nt lds
    s_add_u32 m0, s54, 4224
    s_waitcnt vmcnt(33)
    buffer_load_dwordx4 v28, s[28:31], s61 offen offset:0 nt lds
    s_waitcnt vmcnt(33)
    buffer_load_dwordx4 v29, s[28:31], s61 offen offset:1056 nt lds
    s_waitcnt vmcnt(33)
    buffer_load_dwordx4 v30, s[28:31], s61 offen offset:2112 nt lds
    s_waitcnt vmcnt(33)
    buffer_load_dwordx4 v31, s[28:31], s61 offen offset:3168 nt lds
    s_add_u32 m0, s54, 8448
    s_waitcnt vmcnt(33)
    buffer_load_dwordx4 v28, s[28:31], s62 offen offset:0 nt lds
    s_waitcnt vmcnt(33)
    buffer_load_dwordx4 v29, s[28:31], s62 offen offset:1056 nt lds
    s_waitcnt vmcnt(33)
    buffer_load_dwordx4 v30, s[28:31], s62 offen offset:2112 nt lds
    s_waitcnt vmcnt(33)
    ds_read_b128 v[32:35], v36
    buffer_load_dwordx4 v31, s[28:31], s62 offen offset:3168 nt lds
    s_add_u32 m0, s54, 12672
    s_waitcnt vmcnt(33)
    buffer_load_dwordx4 v28, s[28:31], s63 offen offset:0 nt lds
    s_waitcnt vmcnt(33)
    buffer_load_dwordx4 v29, s[28:31], s63 offen offset:1056 nt lds
    s_waitcnt vmcnt(33)
    buffer_load_dwordx4 v30, s[28:31], s63 offen offset:2112 nt lds
    s_waitcnt vmcnt(33)
    buffer_load_dwordx4 v31, s[28:31], s63 offen offset:3168 nt lds
    s_add_u32 s50, s50, 1
    s_mov_b64 s[60:61], s[56:57]
    s_mov_b64 s[62:63], s[58:59]
    s_cmp_eq_u32 s50, 2
    s_cbranch_scc0 L_tab34
L_tw34:
    ds_read_b128 v[40:43], v36 offset:32
    ds_read_b128 v[20:23], v39
    s_waitcnt lgkmcnt(0)
    v_min3_u32 v40, v40, v41, v42
    v_min_u32 v40, v40, v43
    s_nop 0
    v_readfirstlane_b32 s47, v40
    s_nop 0
    s_cmp_eq_u32 s47, 0
    s_cbranch_scc1 L_tw34
L_tab34:
    v_readlane_b32 s56, v20, s50
    v_readlane_b32 s57, v21, s50
    v_readlane_b32 s58, v22, s50
    v_readlane_b32 s59, v23, s50
    s_add_u32 s53, s53, 17408
    s_cmp_ge_u32 s53, 69632
    s_cselect_b32 s53, 0, s53
    s_add_u32 s54, s54, 16896
    s_cmp_ge_u32 s54, 137216
    s_cselect_b32 s54, 69632, s54
    s_cmp_lt_u32 s50, s51
    s_cbranch_scc1 L_loop34
L_tail34:
    s_sub_i32 s48, s50, 3
    s_branch L_fchkb34
L_fspinb34:
    ds_read_b128 v[32:35], v36
L_fchkb34:
    s_waitcnt lgkmcnt(0)
    v_min_u32 v32, v32, v33
    v_min3_u32 v32, v32, v34, v35
    s_nop 0
    v_readfirstlane_b32 s47, v32
    s_nop 0
    s_cmp_ge_i32 s47, s48
    s_cbranch_scc0 L_fspinb34
    s_add_u32 m0, s54, 0
    s_waitcnt vmcnt(33)
    buffer_load_dwordx4 v28, s[28:31], s60 offen offset:0 nt lds
    s_waitcnt vmcnt(33)
    s_cmp_ge_u32 s50, 2
    s_cbranch_scc0 L_nbvb34
    s_lshl1_add_u32 s52, s50, -3
    v_mov_b32 v37, s52
    ds_write_b32 v36, v37 offset:16
L_nbvb34:
    buffer_load_dwordx4 v29, s[28:31], s60 offen offset:1056 nt lds
    s_waitcnt vmcnt(33)
    buffer_load_dwordx4 v30, s[28:31], s60 offen offset:2112 nt lds
    s_waitcnt vmcnt(33)
    buffer_load_dwordx4 v31, s[28:31], s60 offen offset:3168 nt lds
    s_add_u32 m0, s54, 4224
    s_waitcnt vmcnt(33)
    buffer_load_dwordx4 v28, s[28:31], s61 offen offset:0 nt lds
    s_waitcnt vmcnt(33)
    buffer_load_dwordx4 v29, s[28:31], s61 offen offset:1056 nt lds
    s_waitcnt vmcnt(33)
    buffer_load_dwordx4 v30, s[28:31], s61 offen offset:2112 nt lds
    s_waitcnt vmcnt(33)
    buffer_load_dwordx4 v31, s[28:31], s61 offen offset:3168 nt lds
    s_add_u32 m0, s54, 8448
    s_waitcnt vmcnt(33)
    buffer_load_dwordx4 v28, s[28:31], s62 offen offset:0 nt lds
    s_waitcnt vmcnt(33)
    buffer_load_dwordx4 v29, s[28:31], s62 offen offset:1056 nt lds
    s_waitcnt vmcnt(33)
    buffer_load_dwordx4 v30, s[28:31], s62 offen offset:2112 nt lds
    s_waitcnt vmcnt(33)
    buffer_load_dwordx4 v31, s[28:31], s62 offen offset:3168 nt lds
    s_add_u32 m0, s54, 12672
    s_waitcnt vmcnt(33)
    buffer_load_dwordx4 v28, s[28:31], s63 offen offset:0 nt lds
    s_waitcnt vmcnt(33)
    buffer_load_dwordx4 v29, s[28:31], s63 offen offset:1056 nt lds
    s_waitcnt vmcnt(33)
    buffer_load_dwordx4 v30, s[28:31], s63 offen offset:2112 nt lds
    s_waitcnt vmcnt(33)
    buffer_load_dwordx4 v31, s[28:31], s63 offen offset:3168 nt lds
    s_branch L_drain
L_drain:
    s_lshl_b32 s51, s51, 1
    s_sub_i32 s46, s51, 3
    s_cmp_gt_i32 s46, s52
    s_cbranch_scc0 L_dr3
    s_waitcnt vmcnt(48)
    s_mov_b32 s52, s46
    v_mov_b32 v37, s52
    ds_write_b32 v36, v37 offset:16
L_dr3:
    s_sub_i32 s46, s51, 2
    s_cmp_gt_i32 s46, s52
    s_cbranch_scc0 L_dr2
    s_waitcnt vmcnt(32)
    s_mov_b32 s52, s46
    v_mov_b32 v37, s52
    ds_write_b32 v36, v37 offset:16
L_dr2:
    s_sub_i32 s46, s51, 1
    s_cmp_gt_i32 s46, s52
    s_cbranch_scc0 L_dr1
    s_waitcnt vmcnt(16)
    s_mov_b32 s52, s46
    v_mov_b32 v37, s52
    ds_write_b32 v36, v37 offset:16
L_dr1:
    s_mov_b32 s52, s51
    s_waitcnt vmcnt(8)
    v_mov_b32 v37, s52
    ds_write_b32 v36, v37 offset:16
    s_add_u32 s52, s51, 1
    s_waitcnt vmcnt(0)
    v_mov_b32 v37, s52
    ds_write_b32 v36, v37 offset:16
    s_waitcnt lgkmcnt(0)
    s_endpgm
L_consumer:
    s_sub_u32 s41, s3, 1
    s_lshl_b32 s23, s21, 2
    s_add_u32 s23, s23, s41
    s_lshl_b32 s23, s23, 12
    s_lshl_b32 s22, s20, 17
    s_add_u32 s22, s22, s23
    s_lshl_b32 s23, s20, 2
    v_and_b32 v11, 15, v1
    v_lshrrev_b32 v12, 4, v1
    v_lshlrev_b32 v13, 8, v11
    v_lshl_add_u32 v224, v12, 4, v13
    v_lshlrev_b32 v220, 4, v1
    s_mov_b32 s26, 4194304
    s_mov_b32 s27, 0x20000
    s_waitcnt lgkmcnt(0)
    s_load_dword s48, s[12:13], s23
    s_mov_b32 s32, s10
    s_mov_b32 s33, s11
    s_mov_b32 s34, 16384
    s_mov_b32 s35, 0x20000
    s_lshl_b32 s36, s20, 9
    v_lshlrev_b32 v202, 2, v1
    buffer_load_dword v203, v202, s[32:35], s36 offen offset:256
    buffer_load_dword v202, v202, s[32:35], s36 offen
    s_mov_b32 s24, s4
    s_mov_b32 s25, s5
    buffer_load_dwordx4 v[20:23], v224, s[24:27], s22 offen offset:0
    buffer_load_dwordx4 v[24:27], v224, s[24:27], s22 offen offset:64
    buffer_load_dwordx4 v[28:31], v224, s[24:27], s22 offen offset:128
    buffer_load_dwordx4 v[32:35], v224, s[24:27], s22 offen offset:192
    s_barrier
    v_mov_b32 v223, 137216
    s_lshl_b32 s75, s41, 2
    v_add_u32 v222, s75, v223
    s_waitcnt lgkmcnt(0)
    s_cmp_le_i32 s48, 0
    s_cselect_b32 s49, 2048, s48
    s_min_i32 s49, s49, 2048
    s_add_u32 s51, s49, 63
    s_lshr_b32 s51, s51, 6
    s_sub_u32 s52, s51, 1
    s_add_u32 s36, s49, 15
    s_lshr_b32 s36, s36, 4
    s_sub_u32 s37, s36, 1
    v_mov_b32 v206, v1
    v_add_u32 v207, 64, v1
    v_mov_b32 v208, 0x80000000
    v_cmp_le_u32 s[68:69], 8, v206
    v_cmp_gt_u32 s[70:71], s37, v206
    v_cmp_gt_u32 s[72:73], s37, v207
    v_cmp_gt_u32 s[74:75], s36, v206
    v_cmp_gt_u32 vcc, s36, v207
    s_and_b64 s[68:69], s[68:69], s[70:71]
    s_mul_i32 s38, s41, 4
    s_waitcnt vmcnt(4)
    v_lshrrev_b32 v204, 8, v202
    v_lshrrev_b32 v205, 8, v203
    v_min_u32 v204, 15, v204
    v_min_u32 v205, 15, v205
    v_cndmask_b32 v204, -1, v204, s[68:69]
    v_cndmask_b32 v205, -1, v205, s[72:73]
    v_lshlrev_b32 v202, 15, v202
    v_lshlrev_b32 v203, 15, v203
    v_cndmask_b32 v202, v208, v202, s[74:75]
    v_cndmask_b32 v203, v208, v203, vcc
    v_cmp_gt_u32 s[76:77], s38, v204
    v_cmp_gt_u32 s[78:79], s38, v205
    v_subrev_u32 v204, s38, v204
    v_subrev_u32 v205, s38, v205
    s_bcnt1_i32_b64 s36, s[76:77]
    s_bcnt1_i32_b64 s37, s[78:79]
    s_add_u32 s36, s36, s37
    s_add_u32 s36, s36, 8
    v_cmp_eq_u32 s[76:77], 0, v204
    v_cmp_eq_u32 s[70:71], 0, v205
    v_mov_b32 v208, s36
    s_bcnt1_i32_b64 s37, s[76:77]
    v_mbcnt_lo_u32_b32 v208, s76, v208
    s_add_u32 s36, s36, s37
    v_mbcnt_hi_u32_b32 v208, s77, v208
    v_mov_b32 v209, s36
    v_cndmask_b32 v206, v206, v208, s[76:77]
    v_mbcnt_lo_u32_b32 v209, s70, v209
    s_bcnt1_i32_b64 s37, s[70:71]
    v_mbcnt_hi_u32_b32 v209, s71, v209
    s_add_u32 s36, s36, s37
    v_cndmask_b32 v207, v207, v209, s[70:71]
    v_cmp_eq_u32 s[76:77], 1, v204
    v_cmp_eq_u32 s[70:71], 1, v205
    v_mov_b32 v208, s36
    s_bcnt1_i32_b64 s37, s[76:77]
    v_mbcnt_lo_u32_b32 v208, s76, v208
    s_add_u32 s36, s36, s37
    v_mbcnt_hi_u32_b32 v208, s77, v208
    v_mov_b32 v209, s36
    v_cndmask_b32 v206, v206, v208, s[76:77]
    v_mbcnt_lo_u32_b32 v209, s70, v209
    s_bcnt1_i32_b64 s37, s[70:71]
    v_mbcnt_hi_u32_b32 v209, s71, v209
    s_add_u32 s36, s36, s37
    v_cndmask_b32 v207, v207, v209, s[70:71]
    v_cmp_eq_u32 s[76:77], 2, v204
    v_cmp_eq_u32 s[70:71], 2, v205
    v_mov_b32 v208, s36
    s_bcnt1_i32_b64 s37, s[76:77]
    v_mbcnt_lo_u32_b32 v208, s76, v208
    s_add_u32 s36, s36, s37
    v_mbcnt_hi_u32_b32 v208, s77, v208
    v_mov_b32 v209, s36
    v_cndmask_b32 v206, v206, v208, s[76:77]
    v_mbcnt_lo_u32_b32 v209, s70, v209
    s_bcnt1_i32_b64 s37, s[70:71]
    v_mbcnt_hi_u32_b32 v209, s71, v209
    s_add_u32 s36, s36, s37
    v_cndmask_b32 v207, v207, v209, s[70:71]
    v_cmp_eq_u32 s[76:77], 3, v204
    v_cmp_eq_u32 s[70:71], 3, v205
    v_mov_b32 v208, s36
    s_bcnt1_i32_b64 s37, s[76:77]
    v_mbcnt_lo_u32_b32 v208, s76, v208
    s_add_u32 s36, s36, s37
    v_mbcnt_hi_u32_b32 v208, s77, v208
    v_mov_b32 v209, s36
    v_cndmask_b32 v206, v206, v208, s[76:77]
    v_mbcnt_lo_u32_b32 v209, s70, v209
    s_bcnt1_i32_b64 s37, s[70:71]
    v_mbcnt_hi_u32_b32 v209, s71, v209
    s_add_u32 s36, s36, s37
    v_cndmask_b32 v207, v207, v209, s[70:71]
    v_cmp_gt_u32 s[76:77], 4, v204
    v_cmp_gt_u32 s[78:79], 4, v205
    v_lshl_add_u32 v206, v206, 2, v223
    v_lshl_add_u32 v207, v207, 2, v223
    v_mov_b32 v208, 1
    s_orn2_b64 s[76:77], s[76:77], s[68:69]
    s_orn2_b64 s[78:79], s[78:79], s[72:73]
    s_mov_b64 exec, s[76:77]
    ds_write_b32 v206, v202 offset:48
    s_mov_b64 exec, s[78:79]
    ds_write_b32 v207, v203 offset:48
    s_mov_b64 exec, -1
    ds_write_b32 v222, v208 offset:32
    s_mov_b32 s44, s14
    s_mov_b32 s45, s15
    s_mov_b32 s46, 4194304
    s_mov_b32 s47, 0x20000
    v_mul_u32_u24 v196, 272, v11
    v_lshl_add_u32 v196, v12, 3, v196
    v_mul_u32_u24 v197, 272, v12
    v_lshl_add_u32 v197, v11, 4, v197
    v_lshrrev_b32 v18, 2, v11
    v_and_b32 v17, 3, v11
    v_mul_u32_u24 v7, 1088, v18
    v_lshl_add_u32 v7, v17, 8, v7
    v_xor_b32 v221, v12, v17
    v_lshl_add_u32 v7, v221, 4, v7
    v_mul_u32_u24 v6, 1056, v12
    v_lshl_add_u32 v6, v18, 8, v6
    v_lshl_add_u32 v6, v17, 3, v6
    v_lshlrev_b32 v19, 2, v12
    v_xor_b32 v221, 0, v18
    v_lshl_add_u32 v8, v221, 6, v6
    v_xor_b32 v221, 1, v18
    v_lshl_add_u32 v9, v221, 6, v6
    v_xor_b32 v221, 2, v18
    v_lshl_add_u32 v10, v221, 6, v6
    v_xor_b32 v221, 3, v18
    v_lshl_add_u32 v11, v221, 6, v6
    v_mov_b32 v221, 0xff800000
    v_mov_b32 v216, 0x3f803f80
    v_mov_b32 v217, 0x3f803f80
    v_mov_b32 v218, 0x3f803f80
    v_mov_b32 v219, 0x3f803f80
    s_mov_b32 s60, 0x3e0293ee
    s_mov_b32 s64, 0x40e00000
    s_mov_b32 s65, 0x40004000
    s_lshl_b32 s55, s52, 6
    s_sub_i32 s55, s49, s55
    v_sub_u32 v19, s55, v19
    s_and_b32 s66, s51, 3
    s_mul_i32 s66, s66, 17408
    s_mul_i32 s67, s41, 4352
    s_add_u32 s66, s66, s67
    v_add_u32 v13, s66, v196
    v_add_u32 v16, s66, v197
    v_mov_b32 v156, 0
    v_mov_b32 v157, 0
    v_mov_b32 v158, 0
    v_mov_b32 v159, 0
    v_mov_b32 v160, 0
    v_mov_b32 v161, 0
    v_mov_b32 v162, 0
    v_mov_b32 v163, 0
    v_mov_b32 v164, 0
    v_mov_b32 v165, 0
    v_mov_b32 v166, 0
    v_mov_b32 v167, 0
    v_mov_b32 v168, 0
    v_mov_b32 v169, 0
    v_mov_b32 v170, 0
    v_mov_b32 v171, 0
    v_mov_b32 v172, 0
    v_mov_b32 v173, 0
    v_mov_b32 v174, 0
    v_mov_b32 v175, 0
    v_mov_b32 v176, 0
    v_mov_b32 v177, 0
    v_mov_b32 v178, 0
    v_mov_b32 v179, 0
    v_mov_b32 v180, 0
    v_mov_b32 v181, 0
    v_mov_b32 v182, 0
    v_mov_b32 v183, 0
    v_mov_b32 v184, 0
    v_mov_b32 v185, 0
    v_mov_b32 v186, 0
    v_mov_b32 v187, 0
    v_mov_b32 v212, 0
    v_mov_b32 v213, 0
    v_mov_b32 v214, 0
    v_mov_b32 v215, 0
    v_mov_b32 v228, 0
    v_mov_b32 v229, 0
    v_mov_b32 v230, 0
    v_mov_b32 v231, 0
    v_mov_b32 v232, 0
    v_mov_b32 v233, 0
    v_mov_b32 v234, 0
    v_mov_b32 v235, 0
    v_mov_b32 v236, 0
    v_mov_b32 v237, 0
    v_mov_b32 v238, 0
    v_mov_b32 v239, 0
    v_mov_b32 v240, 0
    v_mov_b32 v241, 0
    v_mov_b32 v242, 0
    v_mov_b32 v243, 0
    s_mov_b32 s53, 0
    s_mov_b32 s54, 69632
    v_mov_b32 v2, v7
    s_mov_b32 s88, 0
    s_mov_b32 s89, 0
    s_mov_b32 s61, 1
    s_mov_b32 s62, 0
    v_mov_b32 v12, 0xf149f2ca
    s_mov_b32 s50, 0
    s_waitcnt vmcnt(0)
    s_cmp_le_i32 s48, 0
    s_cbranch_scc0 L_qok
    v_mov_b32 v20, 0
    v_mov_b32 v21, 0
    v_mov_b32 v22, 0
    v_mov_b32 v23, 0
    v_mov_b32 v24, 0
    v_mov_b32 v25, 0
    v_mov_b32 v26, 0
    v_mov_b32 v27, 0
    v_mov_b32 v28, 0
    v_mov_b32 v29, 0
    v_mov_b32 v30, 0
    v_mov_b32 v31, 0
    v_mov_b32 v32, 0
    v_mov_b32 v33, 0
    v_mov_b32 v34, 0
    v_mov_b32 v35, 0
L_qok:
    s_cmp_eq_u32 s51, 1
    s_cbranch_scc1 L_mask
L_A:
    s_cmp_ge_u32 s62, s61
    s_cbranch_scc1 L_haveA
L_waitA:
    ds_read_b32 v17, v223 offset:16
    s_waitcnt lgkmcnt(0)
    v_readfirstlane_b32 s62, v17
    s_nop 0
    s_cmp_ge_u32 s62, s61
    s_cbranch_scc0 L_waitA
L_haveA:
    ds_read_b128 v[60:63], v2 offset:0
    ds_read_b128 v[64:67], v2 offset:64
    ds_read_b128 v[68:71], v2 offset:128
    ds_read_b128 v[72:75], v2 offset:192
    ds_read_b128 v[76:79], v2 offset:4352
    ds_read_b128 v[80:83], v2 offset:4416
    ds_read_b128 v[84:87], v2 offset:4480
    ds_read_b128 v[88:91], v2 offset:4544
    ds_read_b128 v[92:95], v2 offset:8704
    ds_read_b128 v[96:99], v2 offset:8768
    ds_read_b128 v[100:103], v2 offset:8832
    ds_read_b128 v[104:107], v2 offset:8896
    s_waitcnt lgkmcnt(10)
    v_mfma_f32_16x16x32_bf16 v[36:39], v[60:63], v[20:23], v[228:231]
    v_mfma_f32_16x16x32_bf16 v[36:39], v[64:67], v[24:27], v[36:39]
    s_waitcnt lgkmcnt(8)
    v_mfma_f32_16x16x32_bf16 v[36:39], v[68:71], v[28:31], v[36:39]
    v_mfma_f32_16x16x32_bf16 v[36:39], v[72:75], v[32:35], v[36:39]
    ds_read_b128 v[108:111], v2 offset:13056
    ds_read_b128 v[112:115], v2 offset:13120
    ds_read_b128 v[116:119], v2 offset:13184
    ds_read_b128 v[120:123], v2 offset:13248
    s_waitcnt lgkmcnt(10)
    v_mfma_f32_16x16x32_bf16 v[40:43], v[76:79], v[20:23], v[232:235]
    v_mfma_f32_16x16x32_bf16 v[40:43], v[80:83], v[24:27], v[40:43]
    s_waitcnt lgkmcnt(8)
    v_mfma_f32_16x16x32_bf16 v[40:43], v[84:87], v[28:31], v[40:43]
    v_mfma_f32_16x16x32_bf16 v[40:43], v[88:91], v[32:35], v[40:43]
    s_waitcnt lgkmcnt(6)
    v_mfma_f32_16x16x32_bf16 v[44:47], v[92:95], v[20:23], v[236:239]
    v_mfma_f32_16x16x32_bf16 v[44:47], v[96:99], v[24:27], v[44:47]
    v_fma_f32 v196, v36, s60, -v12
    v_fma_f32 v197, v37, s60, -v12
    v_fma_f32 v198, v38, s60, -v12
    v_fma_f32 v199, v39, s60, -v12
    s_waitcnt lgkmcnt(4)
    v_mfma_f32_16x16x32_bf16 v[44:47], v[100:103], v[28:31], v[44:47]
    v_mfma_f32_16x16x32_bf16 v[44:47], v[104:107], v[32:35], v[44:47]
    v_exp_f32 v196, v196
    v_exp_f32 v197, v197
    v_exp_f32 v198, v198
    v_exp_f32 v199, v199
    s_waitcnt lgkmcnt(2)
    v_mfma_f32_16x16x32_bf16 v[48:51], v[108:111], v[20:23], v[240:243]
    v_mfma_f32_16x16x32_bf16 v[48:51], v[112:115], v[24:27], v[48:51]
    v_fma_f32 v200, v40, s60, -v12
    v_fma_f32 v201, v41, s60, -v12
    v_fma_f32 v202, v42, s60, -v12
    v_fma_f32 v203, v43, s60, -v12
    s_waitcnt lgkmcnt(0)
    v_mfma_f32_16x16x32_bf16 v[48:51], v[116:119], v[28:31], v[48:51]
    v_mfma_f32_16x16x32_bf16 v[48:51], v[120:123], v[32:35], v[48:51]
    v_exp_f32 v200, v200
    v_exp_f32 v201, v201
    v_exp_f32 v202, v202
    v_exp_f32 v203, v203
    v_fma_f32 v204, v44, s60, -v12
    v_fma_f32 v205, v45, s60, -v12
    v_fma_f32 v206, v46, s60, -v12
    v_fma_f32 v207, v47, s60, -v12
    v_cvt_pk_bf16_f32 v188, v196, v197
    v_cvt_pk_bf16_f32 v189, v198, v199
    v_exp_f32 v204, v204
    v_exp_f32 v205, v205
    v_exp_f32 v206, v206
    v_exp_f32 v207, v207
    v_fma_f32 v208, v48, s60, -v12
    v_fma_f32 v209, v49, s60, -v12
    v_fma_f32 v210, v50, s60, -v12
    v_fma_f32 v211, v51, s60, -v12
    v_cvt_pk_bf16_f32 v190, v200, v201
    v_cvt_pk_bf16_f32 v191, v202, v203
    v_exp_f32 v208, v208
    v_exp_f32 v209, v209
    v_exp_f32 v210, v210
    v_exp_f32 v211, v211
    v_cvt_pk_bf16_f32 v192, v204, v205
    v_cvt_pk_bf16_f32 v193, v206, v207
    v_or3_b32 v17, v188, v189, v190
    v_or3_b32 v18, v191, v192, v193
    v_cvt_pk_bf16_f32 v194, v208, v209
    v_cvt_pk_bf16_f32 v195, v210, v211
    v_or3_b32 v17, v17, v18, v194
    v_or_b32 v17, v17, v195
    v_and_b32 v17, s65, v17
    v_cmp_ne_u32 vcc, 0, v17
    s_add_u32 s61, s61, 1
    s_cbranch_vccnz L_slow
L_B:
    s_cmp_eq_u32 s50, 0
    s_cbranch_scc1 L_noB
    s_cmp_ge_u32 s62, s61
    s_cbranch_scc1 L_haveB
L_waitB:
    ds_read_b32 v17, v223 offset:16
    s_waitcnt lgkmcnt(0)
    v_readfirstlane_b32 s62, v17
    s_nop 0
    s_cmp_ge_u32 s62, s61
    s_cbranch_scc0 L_waitB
L_haveB:
    ds_read_b64_tr_b16 v[124:125], v3 offset:0
    ds_read_b64_tr_b16 v[126:127], v3 offset:4224
    ds_read_b64_tr_b16 v[128:129], v3 offset:8448
    ds_read_b64_tr_b16 v[130:131], v3 offset:12672
    ds_read_b64_tr_b16 v[132:133], v3 offset:32
    ds_read_b64_tr_b16 v[134:135], v3 offset:4256
    ds_read_b64_tr_b16 v[136:137], v3 offset:8480
    ds_read_b64_tr_b16 v[138:139], v3 offset:12704
    ds_read_b64_tr_b16 v[140:141], v4 offset:0
    ds_read_b64_tr_b16 v[142:143], v4 offset:4224
    ds_read_b64_tr_b16 v[144:145], v4 offset:8448
    ds_read_b64_tr_b16 v[146:147], v4 offset:12672
    v_mfma_f32_16x16x32_bf16 v[212:215], v[216:219], v[52:55], v[212:215]
    v_mfma_f32_16x16x32_bf16 v[212:215], v[216:219], v[56:59], v[212:215]
    s_waitcnt lgkmcnt(8)
    v_mfma_f32_16x16x32_bf16 v[156:159], v[124:127], v[52:55], v[156:159]
    ds_read_b64_tr_b16 v[148:149], v4 offset:32
    ds_read_b64_tr_b16 v[150:151], v4 offset:4256
    ds_read_b64_tr_b16 v[152:153], v4 offset:8480
    ds_read_b64_tr_b16 v[154:155], v4 offset:12704
    v_mfma_f32_16x16x32_bf16 v[156:159], v[128:131], v[56:59], v[156:159]
    s_waitcnt lgkmcnt(8)
    v_mfma_f32_16x16x32_bf16 v[160:163], v[132:135], v[52:55], v[160:163]
    ds_read_b64_tr_b16 v[60:61], v5 offset:0
    ds_read_b64_tr_b16 v[62:63], v5 offset:4224
    ds_read_b64_tr_b16 v[64:65], v5 offset:8448
    ds_read_b64_tr_b16 v[66:67], v5 offset:12672
    v_mfma_f32_16x16x32_bf16 v[160:163], v[136:139], v[56:59], v[160:163]
    s_waitcnt lgkmcnt(8)
    v_mfma_f32_16x16x32_bf16 v[164:167], v[140:143], v[52:55], v[164:167]
    ds_read_b64_tr_b16 v[68:69], v5 offset:32
    ds_read_b64_tr_b16 v[70:71], v5 offset:4256
    ds_read_b64_tr_b16 v[72:73], v5 offset:8480
    ds_read_b64_tr_b16 v[74:75], v5 offset:12704
    v_mfma_f32_16x16x32_bf16 v[164:167], v[144:147], v[56:59], v[164:167]
    s_waitcnt lgkmcnt(8)
    v_mfma_f32_16x16x32_bf16 v[168:171], v[148:151], v[52:55], v[168:171]
    ds_read_b64_tr_b16 v[76:77], v6 offset:0
    ds_read_b64_tr_b16 v[78:79], v6 offset:4224
    ds_read_b64_tr_b16 v[80:81], v6 offset:8448
    ds_read_b64_tr_b16 v[82:83], v6 offset:12672
    v_mfma_f32_16x16x32_bf16 v[168:171], v[152:155], v[56:59], v[168:171]
    s_waitcnt lgkmcnt(8)
    v_mfma_f32_16x16x32_bf16 v[172:175], v[60:63], v[52:55], v[172:175]
    ds_read_b64_tr_b16 v[84:85], v6 offset:32
    ds_read_b64_tr_b16 v[86:87], v6 offset:4256
    ds_read_b64_tr_b16 v[88:89], v6 offset:8480
    ds_read_b64_tr_b16 v[90:91], v6 offset:12704
    v_mfma_f32_16x16x32_bf16 v[172:175], v[64:67], v[56:59], v[172:175]
    s_waitcnt lgkmcnt(8)
    v_mfma_f32_16x16x32_bf16 v[176:179], v[68:71], v[52:55], v[176:179]
    v_mfma_f32_16x16x32_bf16 v[176:179], v[72:75], v[56:59], v[176:179]
    s_waitcnt lgkmcnt(4)
    v_mfma_f32_16x16x32_bf16 v[180:183], v[76:79], v[52:55], v[180:183]
    v_mfma_f32_16x16x32_bf16 v[180:183], v[80:83], v[56:59], v[180:183]
    s_waitcnt lgkmcnt(0)
    v_mfma_f32_16x16x32_bf16 v[184:187], v[84:87], v[52:55], v[184:187]
    v_mfma_f32_16x16x32_bf16 v[184:187], v[88:91], v[56:59], v[184:187]
    s_add_u32 s61, s61, 1
L_noB:
    s_add_u32 s50, s50, 1
    v_mov_b32 v224, s50
    ds_write_b32 v222, v224
    s_add_u32 s53, s53, 17408
    s_cmp_ge_u32 s53, 69632
    s_cselect_b32 s53, 0, s53
    v_add_u32 v2, s53, v7
    v_add_u32 v3, s54, v8
    v_add_u32 v4, s54, v9
    v_add_u32 v5, s54, v10
    v_add_u32 v6, s54, v11
    s_add_u32 s54, s54, 16896
    s_cmp_ge_u32 s54, 137216
    s_cselect_b32 s54, 69632, s54
    v_mov_b32 v52, v188
    v_mov_b32 v53, v189
    v_mov_b32 v54, v190
    v_mov_b32 v55, v191
    v_mov_b32 v56, v192
    v_mov_b32 v57, v193
    v_mov_b32 v58, v194
    v_mov_b32 v59, v195
    s_cmp_eq_u32 s89, 0
    s_cbranch_scc1 L_nors
    v_pk_mul_f32 v[156:157], v[156:157], v[14:15] op_sel_hi:[1,0]
    v_pk_mul_f32 v[158:159], v[158:159], v[14:15] op_sel_hi:[1,0]
    v_pk_mul_f32 v[160:161], v[160:161], v[14:15] op_sel_hi:[1,0]
    v_pk_mul_f32 v[162:163], v[162:163], v[14:15] op_sel_hi:[1,0]
    v_pk_mul_f32 v[164:165], v[164:165], v[14:15] op_sel_hi:[1,0]
    v_pk_mul_f32 v[166:167], v[166:167], v[14:15] op_sel_hi:[1,0]
    v_pk_mul_f32 v[168:169], v[168:169], v[14:15] op_sel_hi:[1,0]
    v_pk_mul_f32 v[170:171], v[170:171], v[14:15] op_sel_hi:[1,0]
    v_pk_mul_f32 v[172:173], v[172:173], v[14:15] op_sel_hi:[1,0]
    v_pk_mul_f32 v[174:175], v[174:175], v[14:15] op_sel_hi:[1,0]
    v_pk_mul_f32 v[176:177], v[176:177], v[14:15] op_sel_hi:[1,0]
    v_pk_mul_f32 v[178:179], v[178:179], v[14:15] op_sel_hi:[1,0]
    v_pk_mul_f32 v[180:181], v[180:181], v[14:15] op_sel_hi:[1,0]
    v_pk_mul_f32 v[182:183], v[182:183], v[14:15] op_sel_hi:[1,0]
    v_pk_mul_f32 v[184:185], v[184:185], v[14:15] op_sel_hi:[1,0]
    v_pk_mul_f32 v[186:187], v[186:187], v[14:15] op_sel_hi:[1,0]
    v_mul_f32 v212, v212, v14
    s_mov_b32 s89, 0
L_nors:
    s_cmp_lt_u32 s50, s52
    s_cbranch_scc1 L_A
    s_cmp_eq_u32 s50, s52
    s_cbranch_scc0 L_fin
L_mask:
    v_cmp_lt_i32 s[68:69], 0, v19
    v_cmp_lt_i32 s[70:71], 1, v19
    v_cmp_lt_i32 s[72:73], 2, v19
    v_cmp_lt_i32 s[74:75], 3, v19
    v_cndmask_b32 v228, v221, 0, s[68:69]
    v_cndmask_b32 v229, v221, 0, s[70:71]
    v_cndmask_b32 v230, v221, 0, s[72:73]
    v_cndmask_b32 v231, v221, 0, s[74:75]
    v_cmp_lt_i32 s[68:69], 16, v19
    v_cmp_lt_i32 s[70:71], 17, v19
    v_cmp_lt_i32 s[72:73], 18, v19
    v_cmp_lt_i32 s[74:75], 19, v19
    v_cndmask_b32 v232, v221, 0, s[68:69]
    v_cndmask_b32 v233, v221, 0, s[70:71]
    v_cndmask_b32 v234, v221, 0, s[72:73]
    v_cndmask_b32 v235, v221, 0, s[74:75]
    v_cmp_lt_i32 s[68:69], 32, v19
    v_cmp_lt_i32 s[70:71], 33, v19
    v_cmp_lt_i32 s[72:73], 34, v19
    v_cmp_lt_i32 s[74:75], 35, v19
    v_cndmask_b32 v236, v221, 0, s[68:69]
    v_cndmask_b32 v237, v221, 0, s[70:71]
    v_cndmask_b32 v238, v221, 0, s[72:73]
    v_cndmask_b32 v239, v221, 0, s[74:75]
    v_cmp_lt_i32 s[68:69], 48, v19
    v_cmp_lt_i32 s[70:71], 49, v19
    v_cmp_lt_i32 s[72:73], 50, v19
    v_cmp_lt_i32 s[74:75], 51, v19
    v_cndmask_b32 v240, v221, 0, s[68:69]
    v_cndmask_b32 v241, v221, 0, s[70:71]
    v_cndmask_b32 v242, v221, 0, s[72:73]
    v_cndmask_b32 v243, v221, 0, s[74:75]
    s_branch L_A
L_slow:
    v_cmp_eq_u32 s[68:69], 0, v228
    v_cmp_eq_u32 s[70:71], 0, v229
    v_cmp_eq_u32 s[72:73], 0, v230
    v_cmp_eq_u32 s[74:75], 0, v231
    v_cndmask_b32 v36, v221, v36, s[68:69]
    v_cndmask_b32 v37, v221, v37, s[70:71]
    v_cndmask_b32 v38, v221, v38, s[72:73]
    v_cndmask_b32 v39, v221, v39, s[74:75]
    v_cmp_eq_u32 s[68:69], 0, v232
    v_cmp_eq_u32 s[70:71], 0, v233
    v_cmp_eq_u32 s[72:73], 0, v234
    v_cmp_eq_u32 s[74:75], 0, v235
    v_cndmask_b32 v40, v221, v40, s[68:69]
    v_cndmask_b32 v41, v221, v41, s[70:71]
    v_cndmask_b32 v42, v221, v42, s[72:73]
    v_cndmask_b32 v43, v221, v43, s[74:75]
    v_cmp_eq_u32 s[68:69], 0, v236
    v_cmp_eq_u32 s[70:71], 0, v237
    v_cmp_eq_u32 s[72:73], 0, v238
    v_cmp_eq_u32 s[74:75], 0, v239
    v_cndmask_b32 v44, v221, v44, s[68:69]
    v_cndmask_b32 v45, v221, v45, s[70:71]
    v_cndmask_b32 v46, v221, v46, s[72:73]
    v_cndmask_b32 v47, v221, v47, s[74:75]
    v_cmp_eq_u32 s[68:69], 0, v240
    v_cmp_eq_u32 s[70:71], 0, v241
    v_cmp_eq_u32 s[72:73], 0, v242
    v_cmp_eq_u32 s[74:75], 0, v243
    v_cndmask_b32 v48, v221, v48, s[68:69]
    v_cndmask_b32 v49, v221, v49, s[70:71]
    v_cndmask_b32 v50, v221, v50, s[72:73]
    v_cndmask_b32 v51, v221, v51, s[74:75]
    v_max3_f32 v17, v36, v37, v38
    v_max3_f32 v18, v39, v40, v41
    v_max3_f32 v224, v42, v43, v44
    v_max3_f32 v225, v45, v46, v47
    v_max3_f32 v17, v17, v48, v49
    v_max3_f32 v18, v18, v50, v51
    v_max3_f32 v17, v17, v224, v225
    v_max_f32 v17, v17, v18
    v_mov_b32 v18, v17
    s_nop 1
    v_permlane32_swap_b32 v17, v18
    v_max_f32 v17, v17, v18
    v_mov_b32 v18, v17
    s_nop 1
    v_permlane16_swap_b32 v17, v18
    v_max_f32 v17, v17, v18
    v_mov_b32 v18, s64
    v_fma_f32 v17, v17, s60, v18
    v_max_f32 v17, v17, v12
    v_sub_f32 v14, v12, v17
    v_mov_b32 v12, v17
    v_exp_f32 v14, v14
    v_fma_f32 v196, v36, s60, -v12
    v_fma_f32 v197, v37, s60, -v12
    v_fma_f32 v198, v38, s60, -v12
    v_fma_f32 v199, v39, s60, -v12
    v_fma_f32 v200, v40, s60, -v12
    v_fma_f32 v201, v41, s60, -v12
    v_fma_f32 v202, v42, s60, -v12
    v_fma_f32 v203, v43, s60, -v12
    v_fma_f32 v204, v44, s60, -v12
    v_fma_f32 v205, v45, s60, -v12
    v_fma_f32 v206, v46, s60, -v12
    v_fma_f32 v207, v47, s60, -v12
    v_fma_f32 v208, v48, s60, -v12
    v_fma_f32 v209, v49, s60, -v12
    v_fma_f32 v210, v50, s60, -v12
    v_fma_f32 v211, v51, s60, -v12
    v_exp_f32 v196, v196
    v_exp_f32 v197, v197
    v_exp_f32 v198, v198
    v_exp_f32 v199, v199
    v_exp_f32 v200, v200
    v_exp_f32 v201, v201
    v_exp_f32 v202, v202
    v_exp_f32 v203, v203
    v_exp_f32 v204, v204
    v_exp_f32 v205, v205
    v_exp_f32 v206, v206
    v_exp_f32 v207, v207
    v_exp_f32 v208, v208
    v_exp_f32 v209, v209
    v_exp_f32 v210, v210
    v_exp_f32 v211, v211
    v_cvt_pk_bf16_f32 v188, v196, v197
    v_cvt_pk_bf16_f32 v189, v198, v199
    v_cvt_pk_bf16_f32 v190, v200, v201
    v_cvt_pk_bf16_f32 v191, v202, v203
    v_cvt_pk_bf16_f32 v192, v204, v205
    v_cvt_pk_bf16_f32 v193, v206, v207
    v_cvt_pk_bf16_f32 v194, v208, v209
    v_cvt_pk_bf16_f32 v195, v210, v211
    s_mov_b32 s89, 1
    s_branch L_B
L_fin:
    v_mfma_f32_16x16x32_bf16 v[212:215], v[216:219], v[52:55], v[212:215]
    v_mfma_f32_16x16x32_bf16 v[212:215], v[216:219], v[56:59], v[212:215]
    s_cmp_ge_u32 s62, s61
    s_cbranch_scc1 L_haveF0
L_waitF0:
    ds_read_b32 v17, v223 offset:16
    s_waitcnt lgkmcnt(0)
    v_readfirstlane_b32 s62, v17
    s_nop 0
    s_cmp_ge_u32 s62, s61
    s_cbranch_scc0 L_waitF0
L_haveF0:
    ds_read_b64_tr_b16 v[124:125], v3 offset:0
    ds_read_b64_tr_b16 v[126:127], v3 offset:4224
    ds_read_b64_tr_b16 v[132:133], v3 offset:32
    ds_read_b64_tr_b16 v[134:135], v3 offset:4256
    ds_read_b64_tr_b16 v[140:141], v4 offset:0
    ds_read_b64_tr_b16 v[142:143], v4 offset:4224
    ds_read_b64_tr_b16 v[148:149], v4 offset:32
    ds_read_b64_tr_b16 v[150:151], v4 offset:4256
    ds_read_b64_tr_b16 v[60:61], v5 offset:0
    ds_read_b64_tr_b16 v[62:63], v5 offset:4224
    ds_read_b64_tr_b16 v[68:69], v5 offset:32
    ds_read_b64_tr_b16 v[70:71], v5 offset:4256
    ds_read_b64_tr_b16 v[76:77], v6 offset:0
    ds_read_b64_tr_b16 v[78:79], v6 offset:4224
    s_waitcnt lgkmcnt(12)
    v_mfma_f32_16x16x32_bf16 v[156:159], v[124:127], v[52:55], v[156:159]
    ds_read_b64_tr_b16 v[84:85], v6 offset:32
    ds_read_b64_tr_b16 v[86:87], v6 offset:4256
    s_waitcnt lgkmcnt(12)
    v_mfma_f32_16x16x32_bf16 v[160:163], v[132:135], v[52:55], v[160:163]
    s_waitcnt lgkmcnt(10)
    v_mfma_f32_16x16x32_bf16 v[164:167], v[140:143], v[52:55], v[164:167]
    s_waitcnt lgkmcnt(8)
    v_mfma_f32_16x16x32_bf16 v[168:171], v[148:151], v[52:55], v[168:171]
    s_waitcnt lgkmcnt(6)
    v_mfma_f32_16x16x32_bf16 v[172:175], v[60:63], v[52:55], v[172:175]
    s_waitcnt lgkmcnt(4)
    v_mfma_f32_16x16x32_bf16 v[176:179], v[68:71], v[52:55], v[176:179]
    s_waitcnt lgkmcnt(2)
    v_mfma_f32_16x16x32_bf16 v[180:183], v[76:79], v[52:55], v[180:183]
    s_waitcnt lgkmcnt(0)
    v_mfma_f32_16x16x32_bf16 v[184:187], v[84:87], v[52:55], v[184:187]
    v_rcp_f32 v226, v212
    s_add_u32 s61, s61, 1
    s_cmp_ge_u32 s62, s61
    s_cbranch_scc1 L_haveF1
L_waitF1:
    ds_read_b32 v17, v223 offset:16
    s_waitcnt lgkmcnt(0)
    v_readfirstlane_b32 s62, v17
    s_nop 0
    s_cmp_ge_u32 s62, s61
    s_cbranch_scc0 L_waitF1
L_haveF1:
    ds_read_b64_tr_b16 v[128:129], v3 offset:8448
    ds_read_b64_tr_b16 v[130:131], v3 offset:12672
    ds_read_b64_tr_b16 v[136:137], v3 offset:8480
    ds_read_b64_tr_b16 v[138:139], v3 offset:12704
    ds_read_b64_tr_b16 v[144:145], v4 offset:8448
    ds_read_b64_tr_b16 v[146:147], v4 offset:12672
    ds_read_b64_tr_b16 v[152:153], v4 offset:8480
    ds_read_b64_tr_b16 v[154:155], v4 offset:12704
    ds_read_b64_tr_b16 v[64:65], v5 offset:8448
    ds_read_b64_tr_b16 v[66:67], v5 offset:12672
    ds_read_b64_tr_b16 v[72:73], v5 offset:8480
    ds_read_b64_tr_b16 v[74:75], v5 offset:12704
    ds_read_b64_tr_b16 v[80:81], v6 offset:8448
    ds_read_b64_tr_b16 v[82:83], v6 offset:12672
    s_waitcnt lgkmcnt(12)
    v_mfma_f32_16x16x32_bf16 v[156:159], v[128:131], v[56:59], v[156:159]
    ds_read_b64_tr_b16 v[88:89], v6 offset:8480
    ds_read_b64_tr_b16 v[90:91], v6 offset:12704
    s_waitcnt lgkmcnt(12)
    v_mfma_f32_16x16x32_bf16 v[160:163], v[136:139], v[56:59], v[160:163]
    s_waitcnt lgkmcnt(10)
    v_mfma_f32_16x16x32_bf16 v[164:167], v[144:147], v[56:59], v[164:167]
    s_waitcnt lgkmcnt(8)
    v_mfma_f32_16x16x32_bf16 v[168:171], v[152:155], v[56:59], v[168:171]
    s_waitcnt lgkmcnt(6)
    v_mfma_f32_16x16x32_bf16 v[172:175], v[64:67], v[56:59], v[172:175]
    v_pk_mul_f32 v[156:157], v[156:157], v[226:227] op_sel_hi:[1,0]
    v_pk_mul_f32 v[158:159], v[158:159], v[226:227] op_sel_hi:[1,0]
    v_cvt_pk_bf16_f32 v36, v156, v157
    v_cvt_pk_bf16_f32 v37, v158, v159
    ds_write_b64 v13, v[36:37] offset:0
    s_waitcnt lgkmcnt(5)
    v_mfma_f32_16x16x32_bf16 v[176:179], v[72:75], v[56:59], v[176:179]
    v_pk_mul_f32 v[160:161], v[160:161], v[226:227] op_sel_hi:[1,0]
    v_pk_mul_f32 v[162:163], v[162:163], v[226:227] op_sel_hi:[1,0]
    v_cvt_pk_bf16_f32 v38, v160, v161
    v_cvt_pk_bf16_f32 v39, v162, v163
    ds_write_b64 v13, v[38:39] offset:32
    s_waitcnt lgkmcnt(4)
    v_mfma_f32_16x16x32_bf16 v[180:183], v[80:83], v[56:59], v[180:183]
    v_pk_mul_f32 v[164:165], v[164:165], v[226:227] op_sel_hi:[1,0]
    v_pk_mul_f32 v[166:167], v[166:167], v[226:227] op_sel_hi:[1,0]
    v_cvt_pk_bf16_f32 v40, v164, v165
    v_cvt_pk_bf16_f32 v41, v166, v167
    ds_write_b64 v13, v[40:41] offset:64
    s_waitcnt lgkmcnt(3)
    v_mfma_f32_16x16x32_bf16 v[184:187], v[88:91], v[56:59], v[184:187]
    v_pk_mul_f32 v[168:169], v[168:169], v[226:227] op_sel_hi:[1,0]
    v_pk_mul_f32 v[170:171], v[170:171], v[226:227] op_sel_hi:[1,0]
    v_cvt_pk_bf16_f32 v42, v168, v169
    v_cvt_pk_bf16_f32 v43, v170, v171
    ds_write_b64 v13, v[42:43] offset:96
    v_pk_mul_f32 v[172:173], v[172:173], v[226:227] op_sel_hi:[1,0]
    v_pk_mul_f32 v[174:175], v[174:175], v[226:227] op_sel_hi:[1,0]
    v_cvt_pk_bf16_f32 v44, v172, v173
    v_cvt_pk_bf16_f32 v45, v174, v175
    ds_write_b64 v13, v[44:45] offset:128
    v_pk_mul_f32 v[176:177], v[176:177], v[226:227] op_sel_hi:[1,0]
    v_pk_mul_f32 v[178:179], v[178:179], v[226:227] op_sel_hi:[1,0]
    v_cvt_pk_bf16_f32 v46, v176, v177
    v_cvt_pk_bf16_f32 v47, v178, v179
    ds_write_b64 v13, v[46:47] offset:160
    v_pk_mul_f32 v[180:181], v[180:181], v[226:227] op_sel_hi:[1,0]
    v_pk_mul_f32 v[182:183], v[182:183], v[226:227] op_sel_hi:[1,0]
    v_cvt_pk_bf16_f32 v48, v180, v181
    v_cvt_pk_bf16_f32 v49, v182, v183
    ds_write_b64 v13, v[48:49] offset:192
    v_pk_mul_f32 v[184:185], v[184:185], v[226:227] op_sel_hi:[1,0]
    v_pk_mul_f32 v[186:187], v[186:187], v[226:227] op_sel_hi:[1,0]
    v_cvt_pk_bf16_f32 v50, v184, v185
    v_cvt_pk_bf16_f32 v51, v186, v187
    ds_write_b64 v13, v[50:51] offset:224
    ds_read_b128 v[124:127], v16 offset:0
    ds_read_b128 v[128:131], v16 offset:1088
    ds_read_b128 v[132:135], v16 offset:2176
    ds_read_b128 v[136:139], v16 offset:3264
    s_waitcnt lgkmcnt(3)
    buffer_store_dwordx4 v[124:127], v220, s[44:47], s22 offen offset:0
    s_waitcnt lgkmcnt(2)
    buffer_store_dwordx4 v[128:131], v220, s[44:47], s22 offen offset:1024
    s_waitcnt lgkmcnt(1)
    buffer_store_dwordx4 v[132:135], v220, s[44:47], s22 offen offset:2048
    s_waitcnt lgkmcnt(0)
    buffer_store_dwordx4 v[136:139], v220, s[44:47], s22 offen offset:3072
L_done:
    s_endpgm
.section .rodata,"a"
.p2align 6
.amdhsa_kernel standalone__paged_block_table_kv_pagedattention__sampling_kernel
  .amdhsa_next_free_vgpr 248
  .amdhsa_next_free_sgpr 102
  .amdhsa_accum_offset 248
  .amdhsa_group_segment_fixed_size 0
  .amdhsa_kernarg_size 64
  .amdhsa_user_sgpr_count 2
  .amdhsa_user_sgpr_kernarg_segment_ptr 1
  .amdhsa_system_sgpr_workgroup_id_x 1
.end_amdhsa_kernel
```
